```python
import torch

def _softmax(x, axis=-1):
    return torch.softmax(x, dim=axis)
def _gelu(x):
    return torch.nn.functional.gelu(x, approximate="tanh")
def _silu(x):
    return torch.nn.functional.silu(x)
def _sigmoid(x):
    return torch.sigmoid(x)
def _layernorm(x, axis=-1, eps=1e-5):
    m = x.mean(dim=axis, keepdim=True)
    v = x.var(dim=axis, keepdim=True, unbiased=False)
    return (x - m) / torch.sqrt(v + eps)
def _scatter_add(tgt, idx, src, axis=0):
    return tgt.clone().index_add_(axis, idx, src)
def _segment_sum(src, seg, n):
    out = torch.zeros((n,) + src.shape[1:], dtype=src.dtype)
    return out.index_add_(0, seg, src)
def _pad(x, pw):
    flat = tuple(v for pair in reversed(pw) for v in pair)
    return torch.nn.functional.pad(x, flat)

kernel_name = 'gather_scatter__edge_featured_mpnn_mpnn__graph'

def setup_inputs():

    _w = (lambda a: (lambda t: t.to(torch.bfloat16) if t.is_floating_point() else t)(torch.as_tensor(a)))
    N, deg, D, De = 25000, 16, 128, max(16, 1)
    E = N * deg
    H = 2 * D
    return {
        "x": _w((lambda *s: torch.randn(*s, dtype=torch.bfloat16) * 0.05)(N, D)),
        "e_attr": _w((lambda *s: torch.randn(*s, dtype=torch.bfloat16) * 0.8)(E, De)),
        "src": _w((lambda lo, hi, *s: torch.randint(lo, hi, s))(0, N, E).to(torch.int64)),
        "dst": _w((lambda lo, hi, *s: torch.randint(lo, hi, s))(0, N, E).to(torch.int64)),
        "w1": _w((lambda *s: torch.randn(*s, dtype=torch.bfloat16) * 0.8)(2 * D + De, H) * (1.0 / (2 * D + De) ** 0.5)),
        "b1": _w((lambda *s: torch.randn(*s, dtype=torch.bfloat16) * 0.4)(H) * 0.01),
        "w2": _w((lambda *s: torch.randn(*s, dtype=torch.bfloat16) * 0.05)(H, D) * (1.0 / H ** 0.5)),
        "b2": _w((lambda *s: torch.randn(*s, dtype=torch.bfloat16) * 0.05)(D) * 0.01),
    }

def reference(x, e_attr, src, dst, w1, b1, w2, b2):
    N, D = x.shape
    h_src = x[src]
    h_dst = x[dst]
    m_in = torch.concatenate([h_src, h_dst, e_attr], axis=-1)
    h = _silu(m_in @ w1 + b1)
    msg = h @ w2 + b2
    return _segment_sum(msg, dst, N)
```

```asm
; @launch kernel=mpnn_prep_kernel grid=(256,1,1) block=(768,1,1) lds=151936
; @launch kernel=mpnn_edge_kernel grid=(256,1,1) block=(512,1,1) lds=163072
.amdgcn_target "amdgcn-amd-amdhsa--gfx950"
.text
.globl mpnn_prep_kernel
.p2align 8
.type mpnn_prep_kernel,@function
mpnn_prep_kernel:
    s_cmp_ge_u32 s2, 256
    s_cbranch_scc1 L_k1_exit
    s_getpc_b64 s[20:21]
L_pc_k1:
    s_sub_u32 s20, s20, L_pc_k1-mpnn_prep_kernel
    s_subb_u32 s21, s21, 0
    v_lshlrev_b32 v28, 7, v0
    s_mov_b32 s22, L_code_end-mpnn_prep_kernel
    v_cmp_gt_u32 vcc, s22, v28
    s_and_saveexec_b64 s[22:23], vcc
    s_cbranch_execz L_pf_k1
    global_load_dword v29, v28, s[20:21]
L_pf_k1:
    s_mov_b64 exec, s[22:23]
    s_load_dwordx4 s[4:7], s[0:1], 16
    s_load_dwordx2 s[8:9], s[0:1], 0
    s_load_dwordx4 s[12:15], s[0:1], 32
    s_load_dwordx2 s[10:11], s[0:1], 48
    s_load_dwordx2 s[36:37], s[0:1], 80
    v_lshrrev_b32 v1, 6, v0
    s_nop 0
    v_readfirstlane_b32 s40, v1
    s_cmp_lt_u32 s40, 8
    s_cbranch_scc1 L_k1_entry
    v_mov_b32 v8, 0
    v_mov_b32 v9, 0
    v_mov_b32 v10, 0
    v_mov_b32 v11, 0
    v_and_b32 v12, 3, v0
    v_lshlrev_b32 v12, 4, v12
    v_add_u32 v12, 102416, v12
    ds_write_b128 v12, v[8:11]
    v_subrev_u32 v1, 512, v0
    v_lshlrev_b32 v4, 4, v1
    v_add_u32 v5, 4096, v4
    s_mul_i32 s41, s2, 6252
    s_setprio 3
    s_waitcnt lgkmcnt(0)
    s_barrier
    s_mov_b32 s44, s6
    s_and_b32 s45, s7, 0xffff
    s_mov_b32 s46, 1600000
    s_mov_b32 s47, 0x20000
    s_mov_b32 s16, s4
    s_and_b32 s17, s5, 0xffff
    s_mov_b32 s18, 1600000
    s_mov_b32 s19, 0x20000
    buffer_load_dwordx4 v[8:11], v4, s[44:47], s41 offen
    buffer_load_dwordx4 v[12:15], v5, s[44:47], s41 offen
    buffer_load_dwordx4 v[16:19], v4, s[16:19], s41 offen
    buffer_load_dwordx4 v[20:23], v5, s[16:19], s41 offen
    s_branch L_k1_binstart
L_k1_entry:
    s_waitcnt lgkmcnt(0)
    s_barrier
    v_and_b32 v2, 63, v0
    v_and_b32 v3, 31, v0
    v_lshlrev_b32 v4, 4, v2
    v_lshrrev_b32 v5, 5, v2
    s_lshl_b32 s42, s2, 2
    s_mul_i32 s68, s42, 3125
    s_lshr_b32 s68, s68, 7
    s_add_u32 s60, s42, 4
    s_mul_i32 s69, s60, 3125
    s_lshr_b32 s69, s69, 7
    s_mov_b32 s24, s8
    s_and_b32 s25, s9, 0xffff
    s_mov_b32 s26, 6400000
    s_mov_b32 s27, 0x20000
    s_and_b32 s60, s40, 3
    s_lshl_b32 s60, s60, 2
    v_lshrrev_b32 v16, 4, v2
    v_add_u32 v17, s60, v16
    v_and_b32 v18, 15, v2
    v_xor_b32 v18, v18, v17
    v_lshlrev_b32 v18, 4, v18
    v_lshl_add_u32 v18, v16, 8, v18
    s_lshl_b32 s60, s68, 8
    s_lshl_b32 s61, s40, 10
    s_add_u32 s60, s60, s61
    v_add_u32 v18, s60, v18
    s_add_u32 m0, s61, 65536
    s_nop 0
    buffer_load_dwordx4 v18, s[24:27], 0 offen  lds
    s_add_u32 m0, m0, 8192
    v_add_u32 v18, 8192, v18
    buffer_load_dwordx4 v18, s[24:27], 0 offen  lds
    s_add_u32 m0, m0, 8192
    v_add_u32 v18, 8192, v18
    buffer_load_dwordx4 v18, s[24:27], 0 offen  lds
    s_add_u32 m0, m0, 8192
    v_add_u32 v18, 8192, v18
    s_cmp_lt_u32 s40, 2
    s_cbranch_scc0 L_k1_xdone
    buffer_load_dwordx4 v18, s[24:27], 0 offen  lds
L_k1_xdone:
    s_mov_b32 s20, s12
    s_and_b32 s21, s13, 0xffff
    s_mov_b32 s22, 139264
    s_mov_b32 s23, 0x20000
    v_lshlrev_b32 v16, 2, v5
    v_xor_b32 v16, v16, v3
    v_lshlrev_b32 v16, 4, v16
    v_lshl_add_u32 v16, v5, 9, v16
    v_xor_b32 v17, 128, v16
    s_lshl_b32 s60, s40, 13
    s_add_u32 m0, s60, 0
    s_add_u32 s60, s60, 0
    buffer_load_dwordx4 v16, s[20:23], s60 offen offset:0 lds
    buffer_load_dwordx4 v17, s[20:23], s60 offen offset:1024 lds
    buffer_load_dwordx4 v16, s[20:23], s60 offen offset:2048 lds
    buffer_load_dwordx4 v17, s[20:23], s60 offen offset:3072 lds
    s_lshl_b32 s60, s40, 13
    s_add_u32 m0, s60, 4096
    s_add_u32 s60, s60, 4096
    buffer_load_dwordx4 v16, s[20:23], s60 offen offset:0 lds
    buffer_load_dwordx4 v17, s[20:23], s60 offen offset:1024 lds
    buffer_load_dwordx4 v16, s[20:23], s60 offen offset:2048 lds
    buffer_load_dwordx4 v17, s[20:23], s60 offen offset:3072 lds
    s_mov_b32 s28, s36
    s_and_b32 s29, s37, 0xffff
    s_mov_b32 s30, 12800000
    s_mov_b32 s31, 0x20000
    s_lshl_b32 s60, s40, 6
    v_and_b32 v16, 15, v2
    v_lshrrev_b32 v17, 2, v16
    v_lshlrev_b32 v21, 6, v17
    v_lshl_add_u32 v17, v5, 3, v17
    v_lshlrev_b32 v17, 9, v17
    v_and_b32 v16, 3, v16
    v_bfe_u32 v18, v2, 4, 1
    v_lshl_add_u32 v16, v18, 2, v16
    v_lshlrev_b32 v16, 3, v16
    v_add_u32 v16, s60, v16
    v_xor_b32 v16, v16, v21
    v_add_u32 v19, v17, v16
    s_mov_b32 s63, 0xbfb8aa3b
    v_and_b32 v16, 15, v3
    v_xor_b32 v16, v16, v5
    v_lshlrev_b32 v16, 4, v16
    v_lshl_add_u32 v16, v3, 8, v16
    v_add_u32 v6, 65536, v16
    v_xor_b32 v160, 0, v6
    v_xor_b32 v161, 32, v6
    v_xor_b32 v162, 64, v6
    v_xor_b32 v163, 96, v6
    v_xor_b32 v164, 128, v6
    v_xor_b32 v165, 160, v6
    v_xor_b32 v166, 192, v6
    v_xor_b32 v167, 224, v6
    s_lshl_b32 s60, s40, 11
    s_add_u32 s60, s60, 135552
    v_lshrrev_b32 v16, 1, v3
    v_and_b32 v16, 3, v16
    v_lshlrev_b32 v17, 1, v5
    v_xor_b32 v17, v17, v16
    v_lshlrev_b32 v17, 4, v17
    v_lshl_add_u32 v17, v3, 6, v17
    v_add_u32 v17, s60, v17
    v_xor_b32 v18, 16, v17
    v_lshrrev_b32 v21, 2, v2
    v_and_b32 v22, 3, v2
    v_lshrrev_b32 v16, 1, v21
    v_and_b32 v16, 3, v16
    v_xor_b32 v16, v16, v22
    v_lshlrev_b32 v16, 4, v16
    v_lshl_add_u32 v1, v21, 6, v16
    v_add_u32 v1, s60, v1
    s_lshl_b32 s60, s40, 6
    v_lshl_add_u32 v22, v22, 4, s60
    v_add_u32 v21, s68, v21
    v_mov_b32 v23, 0x7ffffff0
    s_waitcnt vmcnt(0)
    s_waitcnt lgkmcnt(0)
    v_mov_b32 v26, 102432
    v_mov_b32 v27, 1
    s_mov_b64 exec, 1
    ds_add_u32 v26, v27
    s_mov_b64 exec, -1
L_k1_g0:
    ds_read_b32 v27, v26
    s_waitcnt lgkmcnt(0)
    v_readfirstlane_b32 s70, v27
    s_cmp_ge_u32 s70, 8
    s_cbranch_scc1 L_k1_g0_ok
    s_sleep 1
    s_branch L_k1_g0
L_k1_g0_ok:
    ds_read_b64_tr_b16 v[32:33], v19 offset:0
    ds_read_b64_tr_b16 v[34:35], v19 offset:2048
    ds_read_b64_tr_b16 v[36:37], v19 offset:8192
    ds_read_b64_tr_b16 v[38:39], v19 offset:10240
    ds_read_b64_tr_b16 v[40:41], v19 offset:16384
    ds_read_b64_tr_b16 v[42:43], v19 offset:18432
    ds_read_b64_tr_b16 v[44:45], v19 offset:24576
    ds_read_b64_tr_b16 v[46:47], v19 offset:26624
    ds_read_b64_tr_b16 v[48:49], v19 offset:32768
    ds_read_b64_tr_b16 v[50:51], v19 offset:34816
    ds_read_b64_tr_b16 v[52:53], v19 offset:40960
    ds_read_b64_tr_b16 v[54:55], v19 offset:43008
    s_waitcnt lgkmcnt(4)
    ds_read_b64_tr_b16 v[56:57], v19 offset:49152
    ds_read_b64_tr_b16 v[58:59], v19 offset:51200
    ds_read_b64_tr_b16 v[60:61], v19 offset:57344
    ds_read_b64_tr_b16 v[62:63], v19 offset:59392
    s_waitcnt lgkmcnt(4)
    ds_read_b128 v[64:67], v160 offset:0
    ds_read_b128 v[68:71], v161 offset:0
    ds_read_b128 v[72:75], v162 offset:0
    ds_read_b128 v[76:79], v163 offset:0
    ds_read_b128 v[80:83], v164 offset:0
    ds_read_b128 v[84:87], v165 offset:0
    ds_read_b128 v[88:91], v166 offset:0
    ds_read_b128 v[92:95], v167 offset:0
    s_waitcnt lgkmcnt(0)
    v_mfma_f32_32x32x16_bf16 v[128:143], v[32:35], v[64:67], 0
    ds_read_b128 v[96:99], v160 offset:8192
    ds_read_b128 v[100:103], v161 offset:8192
    v_mfma_f32_32x32x16_bf16 v[128:143], v[36:39], v[68:71], v[128:143]
    ds_read_b128 v[104:107], v162 offset:8192
    ds_read_b128 v[108:111], v163 offset:8192
    v_mfma_f32_32x32x16_bf16 v[128:143], v[40:43], v[72:75], v[128:143]
    ds_read_b128 v[112:115], v164 offset:8192
    ds_read_b128 v[116:119], v165 offset:8192
    v_mfma_f32_32x32x16_bf16 v[128:143], v[44:47], v[76:79], v[128:143]
    ds_read_b128 v[120:123], v166 offset:8192
    ds_read_b128 v[124:127], v167 offset:8192
    v_mfma_f32_32x32x16_bf16 v[128:143], v[48:51], v[80:83], v[128:143]
    s_nop 0
    v_mfma_f32_32x32x16_bf16 v[128:143], v[52:55], v[84:87], v[128:143]
    v_mfma_f32_32x32x16_bf16 v[128:143], v[56:59], v[88:91], v[128:143]
    v_mfma_f32_32x32x16_bf16 v[128:143], v[60:63], v[92:95], v[128:143]
    s_waitcnt lgkmcnt(0)
    v_mfma_f32_32x32x16_bf16 v[144:159], v[32:35], v[96:99], 0
    ds_read_b128 v[64:67], v160 offset:16384
    ds_read_b128 v[68:71], v161 offset:16384
    ds_read_b128 v[72:75], v162 offset:16384
    ds_read_b128 v[76:79], v163 offset:16384
    ds_read_b128 v[80:83], v164 offset:16384
    ds_read_b128 v[84:87], v165 offset:16384
    ds_read_b128 v[88:91], v166 offset:16384
    v_mfma_f32_32x32x16_bf16 v[144:159], v[36:39], v[100:103], v[144:159]
    ds_read_b128 v[92:95], v167 offset:16384
    s_nop 9
    v_mul_f32 v128, s63, v128
    v_mul_f32 v129, s63, v129
    v_mul_f32 v130, s63, v130
    v_mul_f32 v131, s63, v131
    v_mul_f32 v132, s63, v132
    v_mfma_f32_32x32x16_bf16 v[144:159], v[40:43], v[104:107], v[144:159]
    v_mul_f32 v133, s63, v133
    v_mul_f32 v134, s63, v134
    v_mul_f32 v135, s63, v135
    v_mul_f32 v136, s63, v136
    v_mul_f32 v137, s63, v137
    v_mul_f32 v138, s63, v138
    v_mul_f32 v139, s63, v139
    v_mfma_f32_32x32x16_bf16 v[144:159], v[44:47], v[108:111], v[144:159]
    v_mul_f32 v140, s63, v140
    v_mul_f32 v141, s63, v141
    v_mul_f32 v142, s63, v142
    v_mul_f32 v143, s63, v143
    v_cvt_pk_bf16_f32 v128, v128, v129
    v_cvt_pk_bf16_f32 v129, v130, v131
    v_cvt_pk_bf16_f32 v130, v132, v133
    v_mfma_f32_32x32x16_bf16 v[144:159], v[48:51], v[112:115], v[144:159]
    v_cvt_pk_bf16_f32 v131, v134, v135
    v_cvt_pk_bf16_f32 v132, v136, v137
    v_cvt_pk_bf16_f32 v133, v138, v139
    v_cvt_pk_bf16_f32 v134, v140, v141
    v_cvt_pk_bf16_f32 v135, v142, v143
    ds_write_b128 v17, v[128:131]
    ds_write_b128 v18, v[132:135]
    v_mfma_f32_32x32x16_bf16 v[144:159], v[52:55], v[116:119], v[144:159]
    v_add_u32 v24, 0, v21
    v_cmp_gt_u32 vcc, s69, v24
    v_lshl_add_u32 v25, v24, 9, v22
    v_add_u32 v24, 16, v24
    v_cndmask_b32 v25, v23, v25, vcc
    v_cmp_gt_u32 vcc, s69, v24
    v_lshl_add_u32 v26, v24, 9, v22
    v_mfma_f32_32x32x16_bf16 v[144:159], v[56:59], v[120:123], v[144:159]
    s_waitcnt lgkmcnt(0)
    ds_read_b128 v[8:11], v1
    ds_read_b128 v[12:15], v1 offset:1024
    v_cndmask_b32 v26, v23, v26, vcc
    s_waitcnt lgkmcnt(0)
    buffer_store_dwordx4 v[8:11], v25, s[28:31], 0 offen sc1
    buffer_store_dwordx4 v[12:15], v26, s[28:31], 0 offen sc1
    v_mfma_f32_32x32x16_bf16 v[144:159], v[60:63], v[124:127], v[144:159]
    s_waitcnt lgkmcnt(0)
    v_mfma_f32_32x32x16_bf16 v[128:143], v[32:35], v[64:67], 0
    ds_read_b128 v[96:99], v160 offset:24576
    ds_read_b128 v[100:103], v161 offset:24576
    ds_read_b128 v[104:107], v162 offset:24576
    ds_read_b128 v[108:111], v163 offset:24576
    ds_read_b128 v[112:115], v164 offset:24576
    ds_read_b128 v[116:119], v165 offset:24576
    ds_read_b128 v[120:123], v166 offset:24576
    v_mfma_f32_32x32x16_bf16 v[128:143], v[36:39], v[68:71], v[128:143]
    ds_read_b128 v[124:127], v167 offset:24576
    s_nop 9
    v_mul_f32 v144, s63, v144
    v_mul_f32 v145, s63, v145
    v_mul_f32 v146, s63, v146
    v_mul_f32 v147, s63, v147
    v_mul_f32 v148, s63, v148
    v_mfma_f32_32x32x16_bf16 v[128:143], v[40:43], v[72:75], v[128:143]
    v_mul_f32 v149, s63, v149
    v_mul_f32 v150, s63, v150
    v_mul_f32 v151, s63, v151
    v_mul_f32 v152, s63, v152
    v_mul_f32 v153, s63, v153
    v_mul_f32 v154, s63, v154
    v_mul_f32 v155, s63, v155
    v_mfma_f32_32x32x16_bf16 v[128:143], v[44:47], v[76:79], v[128:143]
    v_mul_f32 v156, s63, v156
    v_mul_f32 v157, s63, v157
    v_mul_f32 v158, s63, v158
    v_mul_f32 v159, s63, v159
    v_cvt_pk_bf16_f32 v144, v144, v145
    v_cvt_pk_bf16_f32 v145, v146, v147
    v_cvt_pk_bf16_f32 v146, v148, v149
    v_mfma_f32_32x32x16_bf16 v[128:143], v[48:51], v[80:83], v[128:143]
    v_cvt_pk_bf16_f32 v147, v150, v151
    v_cvt_pk_bf16_f32 v148, v152, v153
    v_cvt_pk_bf16_f32 v149, v154, v155
    v_cvt_pk_bf16_f32 v150, v156, v157
    v_cvt_pk_bf16_f32 v151, v158, v159
    ds_write_b128 v17, v[144:147]
    ds_write_b128 v18, v[148:151]
    v_mfma_f32_32x32x16_bf16 v[128:143], v[52:55], v[84:87], v[128:143]
    v_add_u32 v24, 32, v21
    v_cmp_gt_u32 vcc, s69, v24
    v_lshl_add_u32 v25, v24, 9, v22
    v_add_u32 v24, 16, v24
    v_cndmask_b32 v25, v23, v25, vcc
    v_cmp_gt_u32 vcc, s69, v24
    v_lshl_add_u32 v26, v24, 9, v22
    v_mfma_f32_32x32x16_bf16 v[128:143], v[56:59], v[88:91], v[128:143]
    s_waitcnt lgkmcnt(0)
    ds_read_b128 v[8:11], v1
    ds_read_b128 v[12:15], v1 offset:1024
    v_cndmask_b32 v26, v23, v26, vcc
    s_waitcnt lgkmcnt(0)
    buffer_store_dwordx4 v[8:11], v25, s[28:31], 0 offen sc1
    buffer_store_dwordx4 v[12:15], v26, s[28:31], 0 offen sc1
    v_mfma_f32_32x32x16_bf16 v[128:143], v[60:63], v[92:95], v[128:143]
    s_waitcnt lgkmcnt(0)
    v_mfma_f32_32x32x16_bf16 v[144:159], v[32:35], v[96:99], 0
    s_nop 9
    v_mul_f32 v128, s63, v128
    v_mul_f32 v129, s63, v129
    v_mul_f32 v130, s63, v130
    v_mul_f32 v131, s63, v131
    v_mul_f32 v132, s63, v132
    v_mfma_f32_32x32x16_bf16 v[144:159], v[36:39], v[100:103], v[144:159]
    v_mul_f32 v133, s63, v133
    v_mul_f32 v134, s63, v134
    v_mul_f32 v135, s63, v135
    v_mul_f32 v136, s63, v136
    v_mul_f32 v137, s63, v137
    v_mul_f32 v138, s63, v138
    v_mfma_f32_32x32x16_bf16 v[144:159], v[40:43], v[104:107], v[144:159]
    v_mul_f32 v139, s63, v139
    v_mul_f32 v140, s63, v140
    v_mul_f32 v141, s63, v141
    v_mul_f32 v142, s63, v142
    v_mul_f32 v143, s63, v143
    v_cvt_pk_bf16_f32 v128, v128, v129
    v_mfma_f32_32x32x16_bf16 v[144:159], v[44:47], v[108:111], v[144:159]
    v_cvt_pk_bf16_f32 v129, v130, v131
    v_cvt_pk_bf16_f32 v130, v132, v133
    v_cvt_pk_bf16_f32 v131, v134, v135
    v_cvt_pk_bf16_f32 v132, v136, v137
    v_cvt_pk_bf16_f32 v133, v138, v139
    v_cvt_pk_bf16_f32 v134, v140, v141
    v_mfma_f32_32x32x16_bf16 v[144:159], v[48:51], v[112:115], v[144:159]
    v_cvt_pk_bf16_f32 v135, v142, v143
    ds_write_b128 v17, v[128:131]
    ds_write_b128 v18, v[132:135]
    v_add_u32 v24, 64, v21
    v_cmp_gt_u32 vcc, s69, v24
    v_lshl_add_u32 v25, v24, 9, v22
    v_mfma_f32_32x32x16_bf16 v[144:159], v[52:55], v[116:119], v[144:159]
    v_add_u32 v24, 16, v24
    v_cndmask_b32 v25, v23, v25, vcc
    v_cmp_gt_u32 vcc, s69, v24
    v_lshl_add_u32 v26, v24, 9, v22
    s_waitcnt lgkmcnt(0)
    ds_read_b128 v[8:11], v1
    v_mfma_f32_32x32x16_bf16 v[144:159], v[56:59], v[120:123], v[144:159]
    ds_read_b128 v[12:15], v1 offset:1024
    v_cndmask_b32 v26, v23, v26, vcc
    s_waitcnt lgkmcnt(0)
    buffer_store_dwordx4 v[8:11], v25, s[28:31], 0 offen sc1
    buffer_store_dwordx4 v[12:15], v26, s[28:31], 0 offen sc1
    v_mfma_f32_32x32x16_bf16 v[144:159], v[60:63], v[124:127], v[144:159]
    s_waitcnt lgkmcnt(0)
    s_nop 15
    v_mul_f32 v144, s63, v144
    v_mul_f32 v145, s63, v145
    v_mul_f32 v146, s63, v146
    v_mul_f32 v147, s63, v147
    v_mul_f32 v148, s63, v148
    v_mul_f32 v149, s63, v149
    v_mul_f32 v150, s63, v150
    v_mul_f32 v151, s63, v151
    v_mul_f32 v152, s63, v152
    v_mul_f32 v153, s63, v153
    v_mul_f32 v154, s63, v154
    v_mul_f32 v155, s63, v155
    v_mul_f32 v156, s63, v156
    v_mul_f32 v157, s63, v157
    v_mul_f32 v158, s63, v158
    v_mul_f32 v159, s63, v159
    v_cvt_pk_bf16_f32 v144, v144, v145
    v_cvt_pk_bf16_f32 v145, v146, v147
    v_cvt_pk_bf16_f32 v146, v148, v149
    v_cvt_pk_bf16_f32 v147, v150, v151
    v_cvt_pk_bf16_f32 v148, v152, v153
    v_cvt_pk_bf16_f32 v149, v154, v155
    v_cvt_pk_bf16_f32 v150, v156, v157
    v_cvt_pk_bf16_f32 v151, v158, v159
    ds_write_b128 v17, v[144:147]
    ds_write_b128 v18, v[148:151]
    v_add_u32 v24, 96, v21
    v_cmp_gt_u32 vcc, s69, v24
    v_lshl_add_u32 v25, v24, 9, v22
    v_add_u32 v24, 16, v24
    v_cndmask_b32 v25, v23, v25, vcc
    v_cmp_gt_u32 vcc, s69, v24
    v_lshl_add_u32 v26, v24, 9, v22
    s_waitcnt lgkmcnt(0)
    ds_read_b128 v[8:11], v1
    ds_read_b128 v[12:15], v1 offset:1024
    v_cndmask_b32 v26, v23, v26, vcc
    s_waitcnt lgkmcnt(0)
    buffer_store_dwordx4 v[8:11], v25, s[28:31], 0 offen sc1
    buffer_store_dwordx4 v[12:15], v26, s[28:31], 0 offen sc1
    s_endpgm
L_k1_binstart:
L_k1_bin:
    s_setprio 3
    v_mov_b32 v24, 0
    v_mov_b32 v25, 0
    v_mov_b32 v26, 0
    v_mov_b32 v27, 0
    v_add_u32 v6, 98304, v4
    ds_write_b128 v6, v[24:27]
    v_mov_b32 v7, 102400
    ds_write_b32 v7, v24
    s_mov_b32 s20, s12
    s_and_b32 s21, s13, 0xffff
    s_mov_b32 s22, 139264
    s_mov_b32 s23, 0x20000
    s_mov_b32 s56, s10
    s_and_b32 s57, s11, 0xffff
    s_mov_b32 s58, 65536
    s_mov_b32 s59, 0x20000
    s_add_u32 s52, s36, 21188608
    s_addc_u32 s53, s37, 0
    s_and_b32 s53, s53, 0xffff
    s_mov_b32 s54, 146432
    s_mov_b32 s55, 0x20000
    s_add_u32 s48, s36, 12800000
    s_addc_u32 s49, s37, 0
    s_and_b32 s49, s49, 0xffff
    s_mov_b32 s50, 8388608
    s_mov_b32 s51, 0x20000
    s_mul_i32 s60, s2, 136
    v_add_u32 v51, s60, v1
    v_and_b32 v52, 3, v51
    v_bfe_u32 v53, v51, 2, 6
    v_and_b32 v54, 31, v53
    v_lshrrev_b32 v55, 5, v53
    v_lshlrev_b32 v57, 3, v55
    v_lshl_add_u32 v57, v52, 1, v57
    v_lshrrev_b32 v56, 8, v51
    v_add_u32 v62, 256, v57
    v_lshlrev_b32 v62, 9, v62
    v_lshl_add_u32 v58, v56, 5, v54
    v_lshl_add_u32 v62, v58, 1, v62
    v_subrev_u32 v58, 18432, v51
    v_bfe_u32 v59, v58, 8, 3
    v_lshl_add_u32 v57, v59, 4, v57
    v_add_u32 v57, 128, v57
    v_lshlrev_b32 v57, 9, v57
    v_lshrrev_b32 v59, 11, v58
    v_lshl_add_u32 v59, v59, 5, v54
    v_lshl_add_u32 v57, v59, 1, v57
    s_movk_i32 s60, 2048
    v_cmp_gt_u32 s[72:73], s60, v51
    s_movk_i32 s60, 18432
    v_cmp_gt_u32 vcc, s60, v51
    v_cndmask_b32 v57, v57, v62, s[72:73]
    v_lshlrev_b32 v63, 2, v51
    v_add_u32 v62, 7168, v63
    v_cndmask_b32 v63, v62, v63, vcc
    s_andn2_b64 s[76:77], vcc, s[72:73]
    v_subrev_u32 v58, 2048, v51
    v_bfe_u32 v59, v58, 8, 2
    v_lshrrev_b32 v60, 12, v58
    v_lshlrev_b32 v59, 4, v59
    v_lshl_add_u32 v59, v60, 6, v59
    v_lshrrev_b32 v60, 1, v52
    v_lshl_add_u32 v59, v60, 3, v59
    v_lshl_add_u32 v59, v55, 2, v59
    v_and_b32 v60, 1, v52
    v_lshl_add_u32 v59, v60, 1, v59
    v_lshlrev_b32 v59, 8, v59
    v_bfe_u32 v60, v58, 10, 2
    v_lshl_add_u32 v60, v60, 5, v54
    v_lshl_add_u32 v59, v60, 1, v59
    v_mov_b32 v60, 0
    v_mov_b32 v61, 0
    s_movk_i32 s60, 136
    v_cmp_gt_u32 s[64:65], s60, v1
    s_and_b64 s[72:73], s[72:73], s[64:65]
    s_and_b64 s[74:75], s[76:77], s[64:65]
    s_andn2_b64 s[66:67], s[64:65], s[74:75]
    s_mov_b32 s63, 5497559
    s_mov_b32 s61, 400000
    s_mul_i32 s62, s2, 1563
    s_sub_u32 s61, s61, s62
    s_min_u32 s69, s61, 1563
    s_waitcnt lgkmcnt(0)
    v_mov_b32 v40, 102416
    v_mov_b32 v41, 1
    s_mov_b64 exec, 1
    ds_add_u32 v40, v41
    s_mov_b64 exec, -1
L_k1_s0:
    ds_read_b32 v41, v40
    s_waitcnt lgkmcnt(0)
    v_readfirstlane_b32 s70, v41
    s_cmp_ge_u32 s70, 4
    s_cbranch_scc1 L_k1_s0_ok
    s_sleep 1
    s_branch L_k1_s0
L_k1_s0_ok:
    s_waitcnt vmcnt(0)
    v_mov_b32 v28, 1
    v_lshlrev_b32 v29, 2, v1
    v_add_u32 v42, 0, v29
    v_lshlrev_b32 v43, 7, v8
    v_add_u32 v43, 127, v43
    v_mul_hi_u32 v64, v43, s63
    v_lshrrev_b32 v64, 2, v64
    v_mul_u32_u24 v43, 3125, v64
    v_lshrrev_b32 v43, 7, v43
    v_sub_u32 v43, v8, v43
    v_lshl_or_b32 v16, v43, 15, v16
    v_lshl_or_b32 v16, v42, 20, v16
    v_cmp_gt_u32 vcc, s69, v42
    v_min_u32 v64, 1024, v64
    v_mov_b32 v43, 1024
    v_cndmask_b32 v64, v43, v64, vcc
    v_lshlrev_b32 v72, 2, v64
    v_add_u32 v72, 98304, v72
    ds_add_rtn_u32 v8, v72, v28
    v_add_u32 v42, 1, v29
    v_lshlrev_b32 v43, 7, v9
    v_add_u32 v43, 127, v43
    v_mul_hi_u32 v65, v43, s63
    v_lshrrev_b32 v65, 2, v65
    v_mul_u32_u24 v43, 3125, v65
    v_lshrrev_b32 v43, 7, v43
    v_sub_u32 v43, v9, v43
    v_lshl_or_b32 v17, v43, 15, v17
    v_lshl_or_b32 v17, v42, 20, v17
    v_cmp_gt_u32 vcc, s69, v42
    v_min_u32 v65, 1024, v65
    v_mov_b32 v43, 1024
    v_cndmask_b32 v65, v43, v65, vcc
    v_lshlrev_b32 v73, 2, v65
    v_add_u32 v73, 98304, v73
    ds_add_rtn_u32 v9, v73, v28
    v_add_u32 v42, 2, v29
    v_lshlrev_b32 v43, 7, v10
    v_add_u32 v43, 127, v43
    v_mul_hi_u32 v66, v43, s63
    v_lshrrev_b32 v66, 2, v66
    v_mul_u32_u24 v43, 3125, v66
    v_lshrrev_b32 v43, 7, v43
    v_sub_u32 v43, v10, v43
    v_lshl_or_b32 v18, v43, 15, v18
    v_lshl_or_b32 v18, v42, 20, v18
    v_cmp_gt_u32 vcc, s69, v42
    v_min_u32 v66, 1024, v66
    v_mov_b32 v43, 1024
    v_cndmask_b32 v66, v43, v66, vcc
    v_lshlrev_b32 v74, 2, v66
    v_add_u32 v74, 98304, v74
    ds_add_rtn_u32 v10, v74, v28
    v_add_u32 v42, 3, v29
    v_lshlrev_b32 v43, 7, v11
    v_add_u32 v43, 127, v43
    v_mul_hi_u32 v67, v43, s63
    v_lshrrev_b32 v67, 2, v67
    v_mul_u32_u24 v43, 3125, v67
    v_lshrrev_b32 v43, 7, v43
    v_sub_u32 v43, v11, v43
    v_lshl_or_b32 v19, v43, 15, v19
    v_lshl_or_b32 v19, v42, 20, v19
    v_cmp_gt_u32 vcc, s69, v42
    v_min_u32 v67, 1024, v67
    v_mov_b32 v43, 1024
    v_cndmask_b32 v67, v43, v67, vcc
    v_lshlrev_b32 v75, 2, v67
    v_add_u32 v75, 98304, v75
    ds_add_rtn_u32 v11, v75, v28
    v_add_u32 v42, 1024, v29
    v_lshlrev_b32 v43, 7, v12
    v_add_u32 v43, 127, v43
    v_mul_hi_u32 v68, v43, s63
    v_lshrrev_b32 v68, 2, v68
    v_mul_u32_u24 v43, 3125, v68
    v_lshrrev_b32 v43, 7, v43
    v_sub_u32 v43, v12, v43
    v_lshl_or_b32 v20, v43, 15, v20
    v_lshl_or_b32 v20, v42, 20, v20
    v_cmp_gt_u32 vcc, s69, v42
    v_min_u32 v68, 1024, v68
    v_mov_b32 v43, 1024
    v_cndmask_b32 v68, v43, v68, vcc
    v_lshlrev_b32 v76, 2, v68
    v_add_u32 v76, 98304, v76
    ds_add_rtn_u32 v12, v76, v28
    v_add_u32 v42, 1025, v29
    v_lshlrev_b32 v43, 7, v13
    v_add_u32 v43, 127, v43
    v_mul_hi_u32 v69, v43, s63
    v_lshrrev_b32 v69, 2, v69
    v_mul_u32_u24 v43, 3125, v69
    v_lshrrev_b32 v43, 7, v43
    v_sub_u32 v43, v13, v43
    v_lshl_or_b32 v21, v43, 15, v21
    v_lshl_or_b32 v21, v42, 20, v21
    v_cmp_gt_u32 vcc, s69, v42
    v_min_u32 v69, 1024, v69
    v_mov_b32 v43, 1024
    v_cndmask_b32 v69, v43, v69, vcc
    v_lshlrev_b32 v77, 2, v69
    v_add_u32 v77, 98304, v77
    ds_add_rtn_u32 v13, v77, v28
    v_add_u32 v42, 1026, v29
    v_lshlrev_b32 v43, 7, v14
    v_add_u32 v43, 127, v43
    v_mul_hi_u32 v70, v43, s63
    v_lshrrev_b32 v70, 2, v70
    v_mul_u32_u24 v43, 3125, v70
    v_lshrrev_b32 v43, 7, v43
    v_sub_u32 v43, v14, v43
    v_lshl_or_b32 v22, v43, 15, v22
    v_lshl_or_b32 v22, v42, 20, v22
    v_cmp_gt_u32 vcc, s69, v42
    v_min_u32 v70, 1024, v70
    v_mov_b32 v43, 1024
    v_cndmask_b32 v70, v43, v70, vcc
    v_lshlrev_b32 v78, 2, v70
    v_add_u32 v78, 98304, v78
    ds_add_rtn_u32 v14, v78, v28
    v_add_u32 v42, 1027, v29
    v_lshlrev_b32 v43, 7, v15
    v_add_u32 v43, 127, v43
    v_mul_hi_u32 v71, v43, s63
    v_lshrrev_b32 v71, 2, v71
    v_mul_u32_u24 v43, 3125, v71
    v_lshrrev_b32 v43, 7, v43
    v_sub_u32 v43, v15, v43
    v_lshl_or_b32 v23, v43, 15, v23
    v_lshl_or_b32 v23, v42, 20, v23
    v_cmp_gt_u32 vcc, s69, v42
    v_min_u32 v71, 1024, v71
    v_mov_b32 v43, 1024
    v_cndmask_b32 v71, v43, v71, vcc
    v_lshlrev_b32 v79, 2, v71
    v_add_u32 v79, 98304, v79
    ds_add_rtn_u32 v15, v79, v28
    s_mov_b64 exec, s[66:67]
    s_cbranch_execz L_k1_noA
    buffer_load_ushort v60, v57, s[20:23], 0 offen
    buffer_load_ushort v61, v57, s[20:23], 0 offen offset:512
L_k1_noA:
    s_mov_b64 exec, s[74:75]
    s_cbranch_execz L_k1_noB
    buffer_load_ushort v60, v59, s[56:59], 0 offen
    buffer_load_ushort v61, v59, s[56:59], 0 offen offset:256
L_k1_noB:
    s_mov_b64 exec, -1
    s_waitcnt lgkmcnt(0)
    v_mov_b32 v40, 102420
    v_mov_b32 v41, 1
    s_mov_b64 exec, 1
    ds_add_u32 v40, v41
    s_mov_b64 exec, -1
L_k1_s1:
    ds_read_b32 v41, v40
    s_waitcnt lgkmcnt(0)
    v_readfirstlane_b32 s70, v41
    s_cmp_ge_u32 s70, 4
    s_cbranch_scc1 L_k1_s1_ok
    s_sleep 1
    s_branch L_k1_s1
L_k1_s1_ok:
    ds_read_b128 v[80:83], v6
    s_waitcnt lgkmcnt(0)
    v_add_u32 v81, v80, v81
    v_add_u32 v82, v81, v82
    v_add_u32 v83, v82, v83
    v_lshl_or_b32 v43, v81, 8, v80
    v_lshl_or_b32 v43, v82, 16, v43
    v_lshl_or_b32 v43, v83, 24, v43
    v_cmp_lt_u32 vcc, 31, v83
    v_add_u32 v87, 1, v82
    v_add_u32 v86, 1, v81
    v_cndmask_b32 v43, v43, -1, vcc
    v_add_u32 v85, 1, v80
    v_mov_b32 v84, 1
    ds_write_b128 v6, v[84:87]
    v_lshlrev_b32 v42, 7, v1
    v_add_u32 v42, 102528, v42
    ds_write_b32 v42, v43
    s_waitcnt lgkmcnt(0)
    v_mov_b32 v40, 102424
    v_mov_b32 v41, 1
    s_mov_b64 exec, 1
    ds_add_u32 v40, v41
    s_mov_b64 exec, -1
L_k1_s2:
    ds_read_b32 v41, v40
    s_waitcnt lgkmcnt(0)
    v_readfirstlane_b32 s70, v41
    s_cmp_ge_u32 s70, 4
    s_cbranch_scc1 L_k1_s2_ok
    s_sleep 1
    s_branch L_k1_s2
L_k1_s2_ok:
    ds_read_b32 v80, v72
    ds_read_b32 v81, v73
    ds_read_b32 v82, v74
    ds_read_b32 v83, v75
    ds_read_b32 v84, v76
    ds_read_b32 v85, v77
    ds_read_b32 v86, v78
    ds_read_b32 v87, v79
    s_waitcnt lgkmcnt(0)
    v_add_u32 v42, v80, v8
    v_min_u32 v42, 31, v42
    v_lshrrev_b32 v43, 2, v64
    v_lshlrev_b32 v43, 7, v43
    v_lshl_add_u32 v42, v42, 2, v43
    v_add_u32 v42, 102528, v42
    ds_write_b32 v42, v16
    v_add_u32 v42, v81, v9
    v_min_u32 v42, 31, v42
    v_lshrrev_b32 v43, 2, v65
    v_lshlrev_b32 v43, 7, v43
    v_lshl_add_u32 v42, v42, 2, v43
    v_add_u32 v42, 102528, v42
    ds_write_b32 v42, v17
    v_add_u32 v42, v82, v10
    v_min_u32 v42, 31, v42
    v_lshrrev_b32 v43, 2, v66
    v_lshlrev_b32 v43, 7, v43
    v_lshl_add_u32 v42, v42, 2, v43
    v_add_u32 v42, 102528, v42
    ds_write_b32 v42, v18
    v_add_u32 v42, v83, v11
    v_min_u32 v42, 31, v42
    v_lshrrev_b32 v43, 2, v67
    v_lshlrev_b32 v43, 7, v43
    v_lshl_add_u32 v42, v42, 2, v43
    v_add_u32 v42, 102528, v42
    ds_write_b32 v42, v19
    v_add_u32 v42, v84, v12
    v_min_u32 v42, 31, v42
    v_lshrrev_b32 v43, 2, v68
    v_lshlrev_b32 v43, 7, v43
    v_lshl_add_u32 v42, v42, 2, v43
    v_add_u32 v42, 102528, v42
    ds_write_b32 v42, v20
    v_add_u32 v42, v85, v13
    v_min_u32 v42, 31, v42
    v_lshrrev_b32 v43, 2, v69
    v_lshlrev_b32 v43, 7, v43
    v_lshl_add_u32 v42, v42, 2, v43
    v_add_u32 v42, 102528, v42
    ds_write_b32 v42, v21
    v_add_u32 v42, v86, v14
    v_min_u32 v42, 31, v42
    v_lshrrev_b32 v43, 2, v70
    v_lshlrev_b32 v43, 7, v43
    v_lshl_add_u32 v42, v42, 2, v43
    v_add_u32 v42, 102528, v42
    ds_write_b32 v42, v22
    v_add_u32 v42, v87, v15
    v_min_u32 v42, 31, v42
    v_lshrrev_b32 v43, 2, v71
    v_lshlrev_b32 v43, 7, v43
    v_lshl_add_u32 v42, v42, 2, v43
    v_add_u32 v42, 102528, v42
    ds_write_b32 v42, v23
    s_waitcnt lgkmcnt(0)
    v_mov_b32 v40, 102428
    v_mov_b32 v41, 1
    s_mov_b64 exec, 1
    ds_add_u32 v40, v41
    s_mov_b64 exec, -1
L_k1_s3:
    ds_read_b32 v41, v40
    s_waitcnt lgkmcnt(0)
    v_readfirstlane_b32 s70, v41
    s_cmp_ge_u32 s70, 4
    s_cbranch_scc1 L_k1_s3_ok
    s_sleep 1
    s_branch L_k1_s3
L_k1_s3_ok:
    v_lshrrev_b32 v44, 2, v1
    v_and_b32 v45, 3, v1
    v_lshlrev_b32 v46, 7, v44
    v_add_u32 v46, 102528, v46
    v_lshl_add_u32 v47, v45, 4, v46
    v_lshlrev_b32 v44, 15, v44
    v_lshl_add_u32 v44, v45, 4, v44
    s_lshl_b32 s60, s2, 7
    s_mov_b32 s62, 0x10000000
    ds_read_b128 v[64:67], v47 offset:0
    ds_read_b32 v96, v46 offset:0
    ds_read_b128 v[68:71], v47 offset:8192
    ds_read_b32 v97, v46 offset:8192
    ds_read_b128 v[72:75], v47 offset:16384
    ds_read_b32 v98, v46 offset:16384
    ds_read_b128 v[76:79], v47 offset:24576
    ds_read_b32 v99, v46 offset:24576
    s_waitcnt lgkmcnt(0)
    ds_read_b128 v[80:83], v47 offset:64
    ds_read_b128 v[84:87], v47 offset:8256
    ds_read_b128 v[88:91], v47 offset:16448
    ds_read_b128 v[92:95], v47 offset:24640
    buffer_store_dwordx4 v[64:67], v44, s[48:51], s60 offen sc1
    s_add_u32 s60, s60, 0x200000
    buffer_store_dwordx4 v[68:71], v44, s[48:51], s60 offen sc1
    s_add_u32 s60, s60, 0x200000
    buffer_store_dwordx4 v[72:75], v44, s[48:51], s60 offen sc1
    s_add_u32 s60, s60, 0x200000
    buffer_store_dwordx4 v[76:79], v44, s[48:51], s60 offen sc1
    s_add_u32 s60, s60, 0x200000
    s_lshl_b32 s60, s2, 7
    s_waitcnt lgkmcnt(0)
    v_cmp_le_u32 vcc, s62, v96
    s_and_saveexec_b64 s[76:77], vcc
    s_cbranch_execz L_k1_nohi0
    buffer_store_dwordx4 v[80:83], v44, s[48:51], s60 offen offset:64 sc1
L_k1_nohi0:
    s_mov_b64 exec, s[76:77]
    s_add_u32 s60, s60, 0x200000
    v_cmp_le_u32 vcc, s62, v97
    s_and_saveexec_b64 s[76:77], vcc
    s_cbranch_execz L_k1_nohi1
    buffer_store_dwordx4 v[84:87], v44, s[48:51], s60 offen offset:64 sc1
L_k1_nohi1:
    s_mov_b64 exec, s[76:77]
    s_add_u32 s60, s60, 0x200000
    v_cmp_le_u32 vcc, s62, v98
    s_and_saveexec_b64 s[76:77], vcc
    s_cbranch_execz L_k1_nohi2
    buffer_store_dwordx4 v[88:91], v44, s[48:51], s60 offen offset:64 sc1
L_k1_nohi2:
    s_mov_b64 exec, s[76:77]
    s_add_u32 s60, s60, 0x200000
    v_cmp_le_u32 vcc, s62, v99
    s_and_saveexec_b64 s[76:77], vcc
    s_cbranch_execz L_k1_nohi3
    buffer_store_dwordx4 v[92:95], v44, s[48:51], s60 offen offset:64 sc1
L_k1_nohi3:
    s_mov_b64 exec, s[76:77]
    s_add_u32 s60, s60, 0x200000
    s_waitcnt vmcnt(4)
    s_mov_b32 s63, 0xbfb8aa3b
    s_mov_b64 exec, s[64:65]
    s_cbranch_execz L_k1_nofrag
    v_lshl_or_b32 v44, v61, 16, v60
    v_lshlrev_b32 v42, 16, v60
    v_lshlrev_b32 v43, 16, v61
    v_mul_f32 v42, s63, v42
    v_mul_f32 v43, s63, v43
    v_cvt_pk_bf16_f32 v45, v42, v43
    s_nop 0
    v_cndmask_b32 v44, v44, v45, s[72:73]
    buffer_store_dword v44, v63, s[52:55], 0 offen
L_k1_nofrag:
    s_mov_b64 exec, -1
    s_cmp_lt_u32 s2, 7
    s_cbranch_scc0 L_k1_exit
    s_cmp_eq_u32 s40, 11
    s_cbranch_scc0 L_k1_exit
    v_and_b32 v2, 63, v0
    s_lshl_b32 s60, s2, 6
    v_add_u32 v16, s60, v2
    v_subrev_u32 v17, 24, v16
    v_cmp_gt_u32 vcc, 8, v17
    v_and_b32 v17, 7, v17
    v_mov_b32 v18, 1
    v_lshlrev_b32 v17, v17, v18
    v_cndmask_b32 v17, 0, v17, vcc
    v_subrev_u32 v19, 64, v16
    v_cmp_le_u32 vcc, 64, v16
    s_nop 1
    v_cndmask_b32 v17, v17, v19, vcc
    v_subrev_u32 v19, 320, v16
    v_lshrrev_b32 v20, 6, v19
    v_lshlrev_b32 v20, 2, v20
    v_bfe_u32 v21, v19, 5, 1
    v_lshl_add_u32 v20, v21, 4, v20
    v_and_b32 v21, 31, v19
    v_sub_u32 v21, v21, v20
    v_and_b32 v22, 3, v21
    v_lshrrev_b32 v23, 1, v21
    v_and_b32 v23, 4, v23
    v_or_b32 v22, v22, v23
    v_lshlrev_b32 v22, v22, v18
    v_and_b32 v23, -12, v21
    v_cmp_eq_u32 vcc, 0, v23
    s_nop 1
    v_cndmask_b32 v22, 0, v22, vcc
    s_movk_i32 s60, 320
    v_cmp_le_u32 vcc, s60, v16
    s_nop 1
    v_cndmask_b32 v17, v17, v22, vcc
    v_bfe_u32 v19, v17, 0, 1
    v_mul_u32_u24 v24, 0x3f80, v19
    v_bfe_u32 v19, v17, 1, 1
    v_mul_u32_u24 v19, 0x3f80, v19
    v_lshl_or_b32 v24, v19, 16, v24
    v_bfe_u32 v19, v17, 2, 1
    v_mul_u32_u24 v25, 0x3f80, v19
    v_bfe_u32 v19, v17, 3, 1
    v_mul_u32_u24 v19, 0x3f80, v19
    v_lshl_or_b32 v25, v19, 16, v25
    v_bfe_u32 v19, v17, 4, 1
    v_mul_u32_u24 v26, 0x3f80, v19
    v_bfe_u32 v19, v17, 5, 1
    v_mul_u32_u24 v19, 0x3f80, v19
    v_lshl_or_b32 v26, v19, 16, v26
    v_bfe_u32 v19, v17, 6, 1
    v_mul_u32_u24 v27, 0x3f80, v19
    v_bfe_u32 v19, v17, 7, 1
    v_mul_u32_u24 v19, 0x3f80, v19
    v_lshl_or_b32 v27, v19, 16, v27
    v_lshlrev_b32 v16, 4, v16
    v_add_u32 v16, 73728, v16
    buffer_store_dwordx4 v[24:27], v16, s[52:55], 0 offen
    s_endpgm
L_k1_exit:
    s_endpgm

.section .rodata,"a"
.p2align 6
.amdhsa_kernel mpnn_prep_kernel
  .amdhsa_next_free_vgpr 168
  .amdhsa_next_free_sgpr 96
  .amdhsa_accum_offset 168
  .amdhsa_group_segment_fixed_size 0
  .amdhsa_kernarg_size 88
  .amdhsa_user_sgpr_count 2
  .amdhsa_user_sgpr_kernarg_segment_ptr 1
  .amdhsa_system_sgpr_workgroup_id_x 1
.end_amdhsa_kernel
.text
.globl mpnn_edge_kernel
.p2align 8
.type mpnn_edge_kernel,@function
mpnn_edge_kernel:
    s_cmp_ge_u32 s2, 256
    s_cbranch_scc1 L_k2_exit
    s_setprio 2
    s_getpc_b64 s[20:21]
L_pc_k2:
    s_sub_u32 s20, s20, L_pc_k2-mpnn_edge_kernel
    s_subb_u32 s21, s21, 0
    v_lshlrev_b32 v5, 7, v0
    s_mov_b32 s22, L_code_end-mpnn_edge_kernel
    v_cmp_gt_u32 vcc, s22, v5
    s_and_saveexec_b64 s[22:23], vcc
    s_cbranch_execz L_pf_k2
    global_load_dword v11, v5, s[20:21]
L_pf_k2:
    s_mov_b64 exec, s[22:23]
    s_load_dwordx2 s[6:7], s[0:1], 80
    s_load_dwordx2 s[4:5], s[0:1], 8
    s_load_dwordx4 s[8:11], s[0:1], 56
    s_load_dwordx2 s[12:13], s[0:1], 0
    s_load_dwordx2 s[14:15], s[0:1], 40
    v_lshrrev_b32 v112, 6, v0
    v_and_b32 v1, 63, v0
    v_and_b32 v2, 31, v0
    v_readfirstlane_b32 s44, v112
    v_lshrrev_b32 v3, 5, v1
    v_lshlrev_b32 v4, 4, v1
    v_lshrrev_b32 v112, 2, v0
    v_lshlrev_b32 v112, 7, v112
    v_and_b32 v113, 3, v0
    v_lshl_add_u32 v112, v113, 4, v112
    v_add_u32 v113, 16384, v112
    s_lshl_b32 s91, s2, 15
    v_lshlrev_b32 v114, 4, v0
    v_mov_b32 v116, -1
    v_mov_b32 v117, -1
    v_mov_b32 v118, -1
    v_mov_b32 v119, -1
    v_mov_b32 v120, 0
    v_mov_b32 v121, 0
    v_mov_b32 v122, 0
    v_mov_b32 v123, 0
    v_mov_b32 v124, 0x20202020
    v_mov_b32 v125, 0x20202020
    v_mov_b32 v126, 0x20202020
    v_mov_b32 v127, 0x20202020
    s_waitcnt lgkmcnt(0)
    s_add_u32 s24, s6, 12800000
    s_addc_u32 s25, s7, 0
    s_and_b32 s25, s25, 0xffff
    s_mov_b32 s26, 8388608
    s_mov_b32 s27, 0x20000
    buffer_load_dwordx4 v[128:131], v112, s[24:27], s91 offen
    buffer_load_dwordx4 v[132:135], v113, s[24:27], s91 offen
    v_mov_b32 v148, v112
    v_mov_b32 v149, v113
    s_mov_b32 s3, s91
    ds_write_b128 v114, v[116:119] offset:6528
    ds_write_b128 v114, v[120:123] offset:22208
    ds_write_b128 v114, v[120:123] offset:30400
    s_movk_i32 s92, 328
    v_cmp_gt_u32 vcc, s92, v0
    s_movk_i32 s93, 96
    v_cmp_gt_u32 s[94:95], s93, v0
    s_mov_b64 exec, vcc
    ds_write_b128 v114, v[116:119] offset:14720
    s_mov_b64 exec, s[94:95]
    ds_write_b128 v114, v[120:123] offset:38592
    s_mov_b64 exec, -1
    s_movk_i32 s92, 140
    v_cmp_gt_u32 vcc, s92, v0
    v_cmp_gt_u32 s[94:95], 52, v0
    s_mov_b64 exec, vcc
    ds_write_b128 v114, v[124:127] offset:19968
    s_mov_b64 exec, s[94:95]
    ds_write_b128 v114, v[120:123] offset:5120
    s_mov_b64 exec, -1
    s_add_u32 s32, s6, 21188608
    s_addc_u32 s33, s7, 0
    s_and_b32 s33, s33, 0xffff
    s_mov_b32 s34, 146432
    s_mov_b32 s35, 0x20000
    s_lshr_b32 s45, s44, 2
    s_and_b32 s46, s44, 3
    s_cmp_lt_u32 s44, 5
    s_cbranch_scc0 L_k2_notab
    s_lshl_b32 m0, s44, 10
    s_lshl_b32 s92, s44, 10
    s_add_u32 s92, s92, 73728
    buffer_load_dwordx4 v4, s[32:35], s92 offen lds
L_k2_notab:
    s_mov_b32 s28, s12
    s_and_b32 s29, s13, 0xffff
    s_mov_b32 s30, 6400000
    s_mov_b32 s31, 0x20000
    s_lshl_b32 s92, s2, 2
    s_lshl_b32 s93, s45, 1
    s_add_u32 s92, s92, s93
    s_lshr_b32 s93, s46, 1
    s_add_u32 s92, s92, s93
    s_mul_i32 s92, s92, 3125
    s_lshr_b32 s92, s92, 7
    s_and_b32 s93, s46, 1
    s_lshl_b32 s93, s93, 4
    s_add_u32 s92, s92, s93
    s_lshl_b32 s92, s92, 8
    s_mul_i32 s93, s44, 15360
    s_add_u32 s93, s93, 50432
    v_lshrrev_b32 v114, 4, v1
    v_and_b32 v115, 15, v1
    v_add_u32 v116, 0, v114
    v_xor_b32 v117, v115, v116
    v_lshlrev_b32 v117, 4, v117
    v_lshl_add_u32 v117, v116, 8, v117
    s_add_u32 m0, s93, 0
    v_add_u32 v117, s92, v117
    buffer_load_dwordx4 v117, s[28:31], 0 offen lds
    v_add_u32 v116, 4, v114
    v_xor_b32 v117, v115, v116
    v_lshlrev_b32 v117, 4, v117
    v_lshl_add_u32 v117, v116, 8, v117
    s_add_u32 m0, s93, 1024
    v_add_u32 v117, s92, v117
    buffer_load_dwordx4 v117, s[28:31], 0 offen lds
    v_add_u32 v116, 8, v114
    v_xor_b32 v117, v115, v116
    v_lshlrev_b32 v117, 4, v117
    v_lshl_add_u32 v117, v116, 8, v117
    s_add_u32 m0, s93, 2048
    v_add_u32 v117, s92, v117
    buffer_load_dwordx4 v117, s[28:31], 0 offen lds
    v_add_u32 v116, 12, v114
    v_xor_b32 v117, v115, v116
    v_lshlrev_b32 v117, 4, v117
    v_lshl_add_u32 v117, v116, 8, v117
    s_add_u32 m0, s93, 3072
    v_add_u32 v117, s92, v117
    buffer_load_dwordx4 v117, s[28:31], 0 offen lds
    s_waitcnt lgkmcnt(0)
    s_barrier
    s_mov_b32 s76, s14
    s_and_b32 s77, s15, 0xffff
    s_mov_b32 s78, 512
    s_mov_b32 s79, 0x20000
    s_mov_b32 s40, s8
    s_and_b32 s41, s9, 0xffff
    s_mov_b32 s42, 256
    s_mov_b32 s43, 0x20000
    s_mov_b32 s20, s4
    s_and_b32 s21, s5, 0xffff
    s_or_b32 s21, s21, 2097152
    s_mov_b32 s22, 400000
    s_mov_b32 s23, 0x20000
    s_mov_b32 s48, s6
    s_and_b32 s49, s7, 0xffff
    s_or_b32 s49, s49, 33554432
    s_mov_b32 s50, 25000
    s_mov_b32 s51, 0x20000
    s_sub_u32 s52, s6, 1024
    s_subb_u32 s53, s7, 0
    s_and_b32 s53, s53, 0xffff
    s_or_b32 s53, s53, 33554432
    s_mov_b32 s54, 25000
    s_mov_b32 s55, 0x20000
    s_sub_u32 s56, s6, 2048
    s_subb_u32 s57, s7, 0
    s_and_b32 s57, s57, 0xffff
    s_or_b32 s57, s57, 33554432
    s_mov_b32 s58, 25000
    s_mov_b32 s59, 0x20000
    s_sub_u32 s60, s6, 3072
    s_subb_u32 s61, s7, 0
    s_and_b32 s61, s61, 0xffff
    s_or_b32 s61, s61, 33554432
    s_mov_b32 s62, 25000
    s_mov_b32 s63, 0x20000
    s_mov_b32 s36, s10
    s_and_b32 s37, s11, 0xffff
    s_mov_b32 s38, 6400000
    s_mov_b32 s39, 0x20000
    s_mul_i32 s85, s44, 15360
    s_add_u32 s85, s85, 40192
    v_lshrrev_b32 v112, 1, v2
    v_and_b32 v112, 7, v112
    v_xor_b32 v112, v112, v3
    v_lshlrev_b32 v113, 7, v2
    s_add_u32 s92, s85, 1024
    v_add_u32 v113, s92, v113
    v_xor_b32 v114, 0, v112
    v_lshl_add_u32 v22, v114, 4, v113
    v_xor_b32 v114, 2, v112
    v_lshl_add_u32 v23, v114, 4, v113
    v_xor_b32 v114, 4, v112
    v_lshl_add_u32 v24, v114, 4, v113
    v_xor_b32 v114, 6, v112
    v_lshl_add_u32 v25, v114, 4, v113
    v_lshlrev_b32 v114, 5, v2
    v_lshl_add_u32 v114, v3, 4, v114
    v_add_u32 v21, s85, v114
    s_mul_i32 s92, s45, 35
    v_lshrrev_b32 v114, 3, v1
    v_lshrrev_b32 v116, 1, v114
    v_xor_b32 v116, v116, v114
    v_and_b32 v116, 4, v116
    v_mul_u32_u24 v116, 3, v116
    v_xor_b32 v115, v114, v116
    s_lshl_b32 s93, s92, 6
    s_add_u32 s93, s93, 6528
    v_lshl_add_u32 v20, v115, 1, s93
    v_lshrrev_b32 v114, 1, v1
    v_lshrrev_b32 v116, 1, v114
    v_xor_b32 v116, v116, v114
    v_and_b32 v116, 4, v116
    v_mul_u32_u24 v116, 3, v116
    v_xor_b32 v115, v114, v116
    s_lshl_b32 s93, s92, 7
    s_add_u32 s94, s93, 11008
    v_lshl_add_u32 v19, v115, 2, s94
    v_lshrrev_b32 v116, 1, v2
    v_xor_b32 v116, v116, v2
    v_and_b32 v116, 4, v116
    v_mul_u32_u24 v116, 3, v116
    v_xor_b32 v115, v2, v116
    s_lshl_b32 s93, s92, 5
    s_add_u32 s93, s93, 19968
    v_add_u32 v18, s93, v115
    v_xor_b32 v116, 1, v3
    v_lshlrev_b32 v12, 7, v116
    v_lshlrev_b32 v115, 6, v3
    v_lshl_add_u32 v115, v2, 1, v115
    s_lshl_b32 s93, s92, 8
    s_add_u32 s93, s93, 22208
    v_add_u32 v14, s93, v115
    v_and_b32 v114, 7, v1
    v_lshrrev_b32 v115, 4, v1
    v_xor_b32 v114, v114, v115
    s_lshl_b32 s92, s46, 7
    v_lshlrev_b32 v115, 4, v114
    v_add_u32 v27, s92, v115
    v_xor_b32 v29, 64, v27
    v_mov_b32 v31, v27
    v_mov_b32 v33, v29
    v_and_b32 v114, 1, v1
    v_lshlrev_b32 v35, 4, v114
    s_mul_i32 s92, s45, 4480
    s_lshl_b32 s93, s46, 5
    s_add_u32 s92, s92, s93
    s_add_u32 s92, s92, 11008
    v_lshrrev_b32 v114, 3, v1
    v_lshl_add_u32 v10, v114, 2, s92
    v_and_b32 v114, 7, v1
    v_lshlrev_b32 v9, 2, v114
    s_mov_b32 s86, 1.0
    s_mov_b32 s87, 1.0
    s_mov_b32 s88, 0xbf317218
    v_lshlrev_b32 v112, 4, v3
    v_sub_u32 v112, v2, v112
    v_subrev_u32 v112, 0, v112
    v_and_b32 v113, 3, v112
    v_lshrrev_b32 v114, 1, v112
    v_and_or_b32 v113, v114, 4, v113
    v_and_b32 v114, -12, v112
    v_cmp_eq_u32 vcc, 0, v114
    v_mov_b32 v115, 16
    v_lshlrev_b32 v113, v113, v115
    v_cndmask_b32 v72, 0, v113, vcc
    v_lshlrev_b32 v112, 4, v3
    v_sub_u32 v112, v2, v112
    v_subrev_u32 v112, 4, v112
    v_and_b32 v113, 3, v112
    v_lshrrev_b32 v114, 1, v112
    v_and_or_b32 v113, v114, 4, v113
    v_and_b32 v114, -12, v112
    v_cmp_eq_u32 vcc, 0, v114
    v_mov_b32 v115, 16
    v_lshlrev_b32 v113, v113, v115
    v_cndmask_b32 v76, 0, v113, vcc
    v_lshrrev_b32 v112, 2, v0
    v_mul_u32_u24 v112, 1563, v112
    v_add_u32 v113, 200064, v112
    v_and_b32 v122, 3, v0
    v_mov_b32 v114, 1
    v_mov_b32 v120, 16
    s_mov_b32 s91, 0x04040404
    v_cmp_ne_u32 s[92:93], 0, v122
    v_mul_lo_u32 v122, v122, s91
    s_lshl_b32 s91, s46, 11
    buffer_load_dwordx4 v[80:83], v4, s[32:35], s91 offen
    buffer_load_dwordx4 v[84:87], v4, s[32:35], s91 offen offset:1024
    s_lshl_b32 s92, s46, 7
    v_lshlrev_b32 v124, 1, v2
    buffer_load_ushort v5, v124, s[76:79], s92 offen
    buffer_load_ushort v6, v124, s[76:79], s92 offen offset:64
    v_and_b32 v124, 127, v0
    v_lshlrev_b32 v125, 1, v124
    buffer_load_ushort v146, v125, s[40:43], 0 offen
    s_lshl_b32 s91, s46, 14
    s_add_u32 s91, s91, 80896
    v_cmp_ne_u32 s[92:93], 0, v122
    s_waitcnt vmcnt(9)
    v_mov_b32_dpp v104, v128 quad_perm:[0,0,0,0] row_mask:0xf bank_mask:0xf
    v_mov_b32_dpp v105, v132 quad_perm:[0,0,0,0] row_mask:0xf bank_mask:0xf
    v_cmp_eq_u32 vcc, -1, v104
    v_cmp_eq_u32 s[94:95], -1, v105
    v_or_b32 v104, 0x80808080, v104
    v_or_b32 v105, 0x80808080, v105
    v_sub_u32 v104, v104, v122
    v_sub_u32 v105, v105, v122
    s_or_b64 vcc, vcc, s[94:95]
    s_cmp_lg_u64 vcc, 0
    s_cbranch_scc0 L_k2_noovf
    v_mov_b32 v115, 0
    ds_write_b32 v115, v114 offset:5376
L_k2_noovf:
    v_subrev_u32 v115, 0x0, v104
    v_cmp_gt_i32 vcc, 0, v115
    s_and_b64 vcc, vcc, s[92:93]
    s_mov_b64 s[64:65], vcc
    v_and_b32 v116, 0x808080, v115
    v_bcnt_u32_b32 v116, v116, 0
    v_sub_u32 v117, 3, v116
    s_mov_b64 exec, vcc
    v_bfe_u32 v116, v128, 11, 4
    v_lshlrev_b32 v116, 2, v116
    v_lshl_add_u32 v160, v117, 6, v116
    ds_add_rtn_u32 v176, v160, v114 offset:5120
    v_bfe_u32 v116, v128, 15, 5
    v_lshlrev_b32 v116, 2, v116
    v_lshl_add_u32 v116, v117, 7, v116
    ds_add_u32 v116, v114 offset:5440
    s_mov_b64 exec, -1
    s_lshl_b32 s6, s46, 14
    s_add_u32 s6, s6, 80896
    buffer_load_dwordx4 v[192:195], v4, s[32:35], s6 offen offset:0
    v_subrev_u32 v115, 0x1010101, v104
    v_cmp_gt_i32 vcc, 0, v115
    s_mov_b64 s[66:67], vcc
    v_and_b32 v116, 0x808080, v115
    v_bcnt_u32_b32 v116, v116, 0
    v_sub_u32 v117, 3, v116
    s_mov_b64 exec, vcc
    v_bfe_u32 v116, v129, 11, 4
    v_lshlrev_b32 v116, 2, v116
    v_lshl_add_u32 v161, v117, 6, v116
    ds_add_rtn_u32 v177, v161, v114 offset:5120
    v_bfe_u32 v116, v129, 15, 5
    v_lshlrev_b32 v116, 2, v116
    v_lshl_add_u32 v116, v117, 7, v116
    ds_add_u32 v116, v114 offset:5440
    s_mov_b64 exec, -1
    buffer_load_dwordx4 v[196:199], v4, s[32:35], s6 offen offset:1024
    v_subrev_u32 v115, 0x2020202, v104
    v_cmp_gt_i32 vcc, 0, v115
    s_mov_b64 s[68:69], vcc
    v_and_b32 v116, 0x808080, v115
    v_bcnt_u32_b32 v116, v116, 0
    v_sub_u32 v117, 3, v116
    s_mov_b64 exec, vcc
    v_bfe_u32 v116, v130, 11, 4
    v_lshlrev_b32 v116, 2, v116
    v_lshl_add_u32 v162, v117, 6, v116
    ds_add_rtn_u32 v178, v162, v114 offset:5120
    v_bfe_u32 v116, v130, 15, 5
    v_lshlrev_b32 v116, 2, v116
    v_lshl_add_u32 v116, v117, 7, v116
    ds_add_u32 v116, v114 offset:5440
    s_mov_b64 exec, -1
    buffer_load_dwordx4 v[200:203], v4, s[32:35], s6 offen offset:2048
    v_subrev_u32 v115, 0x3030303, v104
    v_cmp_gt_i32 vcc, 0, v115
    s_mov_b64 s[70:71], vcc
    v_and_b32 v116, 0x808080, v115
    v_bcnt_u32_b32 v116, v116, 0
    v_sub_u32 v117, 3, v116
    s_mov_b64 exec, vcc
    v_bfe_u32 v116, v131, 11, 4
    v_lshlrev_b32 v116, 2, v116
    v_lshl_add_u32 v163, v117, 6, v116
    ds_add_rtn_u32 v179, v163, v114 offset:5120
    v_bfe_u32 v116, v131, 15, 5
    v_lshlrev_b32 v116, 2, v116
    v_lshl_add_u32 v116, v117, 7, v116
    ds_add_u32 v116, v114 offset:5440
    s_mov_b64 exec, -1
    buffer_load_dwordx4 v[204:207], v4, s[32:35], s6 offen offset:3072
    s_add_u32 s6, s6, 4096
    s_waitcnt lgkmcnt(4)
    v_subrev_u32 v115, 0x0, v105
    v_cmp_gt_i32 vcc, 0, v115
    s_and_b64 vcc, vcc, s[92:93]
    s_mov_b64 s[72:73], vcc
    v_and_b32 v116, 0x808080, v115
    v_bcnt_u32_b32 v116, v116, 0
    v_sub_u32 v117, 3, v116
    s_mov_b64 exec, vcc
    v_bfe_u32 v116, v132, 11, 4
    v_lshlrev_b32 v116, 2, v116
    v_lshl_add_u32 v164, v117, 6, v116
    ds_add_rtn_u32 v180, v164, v114 offset:5120
    v_bfe_u32 v116, v132, 15, 5
    v_lshlrev_b32 v116, 2, v116
    v_lshl_add_u32 v116, v117, 7, v116
    ds_add_u32 v116, v114 offset:5440
    s_mov_b64 exec, -1
    buffer_load_dwordx4 v[208:211], v4, s[32:35], s6 offen offset:0
    v_subrev_u32 v115, 0x1010101, v105
    v_cmp_gt_i32 vcc, 0, v115
    s_mov_b64 s[74:75], vcc
    v_and_b32 v116, 0x808080, v115
    v_bcnt_u32_b32 v116, v116, 0
    v_sub_u32 v117, 3, v116
    s_mov_b64 exec, vcc
    v_bfe_u32 v116, v133, 11, 4
    v_lshlrev_b32 v116, 2, v116
    v_lshl_add_u32 v165, v117, 6, v116
    ds_add_rtn_u32 v181, v165, v114 offset:5120
    v_bfe_u32 v116, v133, 15, 5
    v_lshlrev_b32 v116, 2, v116
    v_lshl_add_u32 v116, v117, 7, v116
    ds_add_u32 v116, v114 offset:5440
    s_mov_b64 exec, -1
    buffer_load_dwordx4 v[212:215], v4, s[32:35], s6 offen offset:1024
    v_subrev_u32 v115, 0x2020202, v105
    v_cmp_gt_i32 vcc, 0, v115
    s_mov_b64 s[76:77], vcc
    v_and_b32 v116, 0x808080, v115
    v_bcnt_u32_b32 v116, v116, 0
    v_sub_u32 v117, 3, v116
    s_mov_b64 exec, vcc
    v_bfe_u32 v116, v134, 11, 4
    v_lshlrev_b32 v116, 2, v116
    v_lshl_add_u32 v166, v117, 6, v116
    ds_add_rtn_u32 v182, v166, v114 offset:5120
    v_bfe_u32 v116, v134, 15, 5
    v_lshlrev_b32 v116, 2, v116
    v_lshl_add_u32 v116, v117, 7, v116
    ds_add_u32 v116, v114 offset:5440
    s_mov_b64 exec, -1
    buffer_load_dwordx4 v[216:219], v4, s[32:35], s6 offen offset:2048
    v_subrev_u32 v115, 0x3030303, v105
    v_cmp_gt_i32 vcc, 0, v115
    s_mov_b64 s[78:79], vcc
    v_and_b32 v116, 0x808080, v115
    v_bcnt_u32_b32 v116, v116, 0
    v_sub_u32 v117, 3, v116
    s_mov_b64 exec, vcc
    v_bfe_u32 v116, v135, 11, 4
    v_lshlrev_b32 v116, 2, v116
    v_lshl_add_u32 v167, v117, 6, v116
    ds_add_rtn_u32 v183, v167, v114 offset:5120
    v_bfe_u32 v116, v135, 15, 5
    v_lshlrev_b32 v116, 2, v116
    v_lshl_add_u32 v116, v117, 7, v116
    ds_add_u32 v116, v114 offset:5440
    s_mov_b64 exec, -1
    buffer_load_dwordx4 v[220:223], v4, s[32:35], s6 offen offset:3072
    s_add_u32 s6, s6, 4096
    v_subrev_u32 v115, 0x10101010, v104
    v_subrev_u32 v116, 0x10101010, v105
    v_or_b32 v115, v115, v116
    v_cmp_gt_i32 vcc, 0, v115
    s_cmp_lg_u64 vcc, 0
    s_mov_b32 s47, s3
    s_cselect_b32 s3, 1, 0
    s_cbranch_scc0 L_k2_p1done
    buffer_load_dwordx4 v[136:139], v148, s[24:27], s47 offen offset:64
    buffer_load_dwordx4 v[140:143], v149, s[24:27], s47 offen offset:64
    s_waitcnt vmcnt(0) lgkmcnt(0)
    v_subrev_u32 v115, 0x10101010, v104
    v_cmp_gt_i32 vcc, 0, v115
    v_and_b32 v116, 0x808080, v115
    v_bcnt_u32_b32 v116, v116, 0
    v_sub_u32 v117, 3, v116
    s_mov_b64 exec, vcc
    v_bfe_u32 v116, v136, 11, 4
    v_lshlrev_b32 v116, 2, v116
    v_lshl_add_u32 v168, v117, 6, v116
    ds_add_rtn_u32 v184, v168, v114 offset:5120
    v_bfe_u32 v116, v136, 15, 5
    v_lshlrev_b32 v116, 2, v116
    v_lshl_add_u32 v116, v117, 7, v116
    ds_add_u32 v116, v114 offset:5440
    s_mov_b64 exec, -1
    v_subrev_u32 v115, 0x11111111, v104
    v_cmp_gt_i32 vcc, 0, v115
    v_and_b32 v116, 0x808080, v115
    v_bcnt_u32_b32 v116, v116, 0
    v_sub_u32 v117, 3, v116
    s_mov_b64 exec, vcc
    v_bfe_u32 v116, v137, 11, 4
    v_lshlrev_b32 v116, 2, v116
    v_lshl_add_u32 v169, v117, 6, v116
    ds_add_rtn_u32 v185, v169, v114 offset:5120
    v_bfe_u32 v116, v137, 15, 5
    v_lshlrev_b32 v116, 2, v116
    v_lshl_add_u32 v116, v117, 7, v116
    ds_add_u32 v116, v114 offset:5440
    s_mov_b64 exec, -1
    v_subrev_u32 v115, 0x12121212, v104
    v_cmp_gt_i32 vcc, 0, v115
    v_and_b32 v116, 0x808080, v115
    v_bcnt_u32_b32 v116, v116, 0
    v_sub_u32 v117, 3, v116
    s_mov_b64 exec, vcc
    v_bfe_u32 v116, v138, 11, 4
    v_lshlrev_b32 v116, 2, v116
    v_lshl_add_u32 v170, v117, 6, v116
    ds_add_rtn_u32 v186, v170, v114 offset:5120
    v_bfe_u32 v116, v138, 15, 5
    v_lshlrev_b32 v116, 2, v116
    v_lshl_add_u32 v116, v117, 7, v116
    ds_add_u32 v116, v114 offset:5440
    s_mov_b64 exec, -1
    v_subrev_u32 v115, 0x13131313, v104
    v_cmp_gt_i32 vcc, 0, v115
    v_and_b32 v116, 0x808080, v115
    v_bcnt_u32_b32 v116, v116, 0
    v_sub_u32 v117, 3, v116
    s_mov_b64 exec, vcc
    v_bfe_u32 v116, v139, 11, 4
    v_lshlrev_b32 v116, 2, v116
    v_lshl_add_u32 v171, v117, 6, v116
    ds_add_rtn_u32 v187, v171, v114 offset:5120
    v_bfe_u32 v116, v139, 15, 5
    v_lshlrev_b32 v116, 2, v116
    v_lshl_add_u32 v116, v117, 7, v116
    ds_add_u32 v116, v114 offset:5440
    s_mov_b64 exec, -1
    s_waitcnt lgkmcnt(0)
    v_subrev_u32 v115, 0x10101010, v105
    v_cmp_gt_i32 vcc, 0, v115
    v_and_b32 v116, 0x808080, v115
    v_bcnt_u32_b32 v116, v116, 0
    v_sub_u32 v117, 3, v116
    s_mov_b64 exec, vcc
    v_bfe_u32 v116, v140, 11, 4
    v_lshlrev_b32 v116, 2, v116
    v_lshl_add_u32 v172, v117, 6, v116
    ds_add_rtn_u32 v188, v172, v114 offset:5120
    v_bfe_u32 v116, v140, 15, 5
    v_lshlrev_b32 v116, 2, v116
    v_lshl_add_u32 v116, v117, 7, v116
    ds_add_u32 v116, v114 offset:5440
    s_mov_b64 exec, -1
    v_subrev_u32 v115, 0x11111111, v105
    v_cmp_gt_i32 vcc, 0, v115
    v_and_b32 v116, 0x808080, v115
    v_bcnt_u32_b32 v116, v116, 0
    v_sub_u32 v117, 3, v116
    s_mov_b64 exec, vcc
    v_bfe_u32 v116, v141, 11, 4
    v_lshlrev_b32 v116, 2, v116
    v_lshl_add_u32 v173, v117, 6, v116
    ds_add_rtn_u32 v189, v173, v114 offset:5120
    v_bfe_u32 v116, v141, 15, 5
    v_lshlrev_b32 v116, 2, v116
    v_lshl_add_u32 v116, v117, 7, v116
    ds_add_u32 v116, v114 offset:5440
    s_mov_b64 exec, -1
    v_subrev_u32 v115, 0x12121212, v105
    v_cmp_gt_i32 vcc, 0, v115
    v_and_b32 v116, 0x808080, v115
    v_bcnt_u32_b32 v116, v116, 0
    v_sub_u32 v117, 3, v116
    s_mov_b64 exec, vcc
    v_bfe_u32 v116, v142, 11, 4
    v_lshlrev_b32 v116, 2, v116
    v_lshl_add_u32 v174, v117, 6, v116
    ds_add_rtn_u32 v190, v174, v114 offset:5120
    v_bfe_u32 v116, v142, 15, 5
    v_lshlrev_b32 v116, 2, v116
    v_lshl_add_u32 v116, v117, 7, v116
    ds_add_u32 v116, v114 offset:5440
    s_mov_b64 exec, -1
    v_subrev_u32 v115, 0x13131313, v105
    v_cmp_gt_i32 vcc, 0, v115
    v_and_b32 v116, 0x808080, v115
    v_bcnt_u32_b32 v116, v116, 0
    v_sub_u32 v117, 3, v116
    s_mov_b64 exec, vcc
    v_bfe_u32 v116, v143, 11, 4
    v_lshlrev_b32 v116, 2, v116
    v_lshl_add_u32 v175, v117, 6, v116
    ds_add_rtn_u32 v191, v175, v114 offset:5120
    v_bfe_u32 v116, v143, 15, 5
    v_lshlrev_b32 v116, 2, v116
    v_lshl_add_u32 v116, v117, 7, v116
    ds_add_u32 v116, v114 offset:5440
    s_mov_b64 exec, -1
    s_waitcnt lgkmcnt(0)
L_k2_p1done:
    s_waitcnt vmcnt(13) lgkmcnt(0)
    s_barrier
    buffer_load_dwordx4 v[224:227], v4, s[32:35], s6 offen offset:0
    buffer_load_dwordx4 v[228:231], v4, s[32:35], s6 offen offset:1024
    buffer_load_dwordx4 v[232:235], v4, s[32:35], s6 offen offset:2048
    buffer_load_dwordx4 v[236:239], v4, s[32:35], s6 offen offset:3072
    s_add_u32 s6, s6, 4096
    buffer_load_dwordx4 v[240:243], v4, s[32:35], s6 offen offset:0
    buffer_load_dwordx4 v[244:247], v4, s[32:35], s6 offen offset:1024
    buffer_load_dwordx4 v[248:251], v4, s[32:35], s6 offen offset:2048
    buffer_load_dwordx4 v[252:255], v4, s[32:35], s6 offen offset:3072
    ds_read_b128 v[72:75], v72 offset:1024
    ds_read_b128 v[76:79], v76 offset:1024
    v_lshlrev_b32 v115, 2, v1
    ds_read_b32 v116, v115 offset:5120
    v_mov_b32 v118, 0
    ds_read_b32 v119, v118 offset:5376
    s_waitcnt lgkmcnt(0)
    v_mov_b32 v117, v116
    s_nop 1
    v_add_u32_dpp v117, v117, v117 row_shr:1 row_mask:0xf bank_mask:0xf bound_ctrl:0
    s_nop 1
    v_add_u32_dpp v117, v117, v117 row_shr:2 row_mask:0xf bank_mask:0xf bound_ctrl:0
    s_nop 1
    v_add_u32_dpp v117, v117, v117 row_shr:4 row_mask:0xf bank_mask:0xf bound_ctrl:0
    s_nop 1
    v_add_u32_dpp v117, v117, v117 row_shr:8 row_mask:0xf bank_mask:0xf bound_ctrl:0
    v_readfirstlane_b32 s94, v119
    s_nop 0
    v_readlane_b32 s12, v117, 15
    v_readlane_b32 s13, v117, 31
    v_readlane_b32 s14, v117, 47
    v_readlane_b32 s15, v117, 63
    v_sub_u32 v117, v117, v116
    s_add_u32 s12, s12, 31
    s_lshr_b32 s12, s12, 5
    s_add_u32 s13, s13, 31
    s_lshr_b32 s13, s13, 5
    s_add_u32 s14, s14, 31
    s_lshr_b32 s14, s14, 5
    s_add_u32 s15, s15, 31
    s_lshr_b32 s15, s15, 5
    s_add_u32 s92, s12, s13
    s_add_u32 s93, s14, s15
    s_max_u32 s92, s92, s93
    s_cmp_gt_u32 s92, 31
    s_cbranch_scc1 L_k2_slow
    s_cmp_lg_u32 s94, 0
    s_cbranch_scc1 L_k2_slow
    s_cmp_eq_u32 s45, 0
    s_cselect_b32 s83, s12, s14
    s_cselect_b32 s84, s13, s15
    s_add_u32 s84, s84, s83
    s_lshl_b32 s12, s12, 5
    s_lshl_b32 s14, s14, 5
    s_add_u32 s14, s14, 1120
    v_lshrrev_b32 v118, 4, v1
    v_mov_b32 v119, 0
    v_cmp_eq_u32 vcc, 1, v118
    v_mov_b32 v123, s12
    v_cmp_eq_u32 s[92:93], 2, v118
    v_cndmask_b32 v119, v119, v123, vcc
    v_mov_b32 v123, 1120
    v_cmp_eq_u32 vcc, 3, v118
    v_cndmask_b32 v119, v119, v123, s[92:93]
    v_mov_b32 v123, s14
    s_nop 0
    v_cndmask_b32 v119, v119, v123, vcc
    v_add_u32 v122, v117, v119
    v_and_b32 v115, 3, v0
    v_cmp_ne_u32 s[92:93], 0, v115
    ds_bpermute_b32 v160, v160, v122
    ds_bpermute_b32 v161, v161, v122
    ds_bpermute_b32 v162, v162, v122
    ds_bpermute_b32 v163, v163, v122
    ds_bpermute_b32 v164, v164, v122
    ds_bpermute_b32 v165, v165, v122
    ds_bpermute_b32 v166, v166, v122
    ds_bpermute_b32 v167, v167, v122
    s_waitcnt lgkmcnt(0)
    s_mov_b64 exec, s[64:65]
    v_add_u32 v160, v160, v176
    v_and_b32 v118, 0x7fff, v128
    v_lshlrev_b32 v116, 1, v160
    ds_write_b16 v116, v118 offset:6528
    v_lshrrev_b32 v118, 20, v128
    v_lshlrev_b32 v116, 2, v160
    v_add_u32 v118, v118, v112
    ds_write_b32 v116, v118 offset:11008
    v_bfe_u32 v118, v128, 15, 5
    v_lshl_or_b32 v160, v118, 16, v160
    s_mov_b64 exec, s[66:67]
    v_add_u32 v161, v161, v177
    v_and_b32 v118, 0x7fff, v129
    v_lshlrev_b32 v116, 1, v161
    ds_write_b16 v116, v118 offset:6528
    v_lshrrev_b32 v118, 20, v129
    v_lshlrev_b32 v116, 2, v161
    v_add_u32 v118, v118, v112
    ds_write_b32 v116, v118 offset:11008
    v_bfe_u32 v118, v129, 15, 5
    v_lshl_or_b32 v161, v118, 16, v161
    s_mov_b64 exec, s[68:69]
    v_add_u32 v162, v162, v178
    v_and_b32 v118, 0x7fff, v130
    v_lshlrev_b32 v116, 1, v162
    ds_write_b16 v116, v118 offset:6528
    v_lshrrev_b32 v118, 20, v130
    v_lshlrev_b32 v116, 2, v162
    v_add_u32 v118, v118, v112
    ds_write_b32 v116, v118 offset:11008
    v_bfe_u32 v118, v130, 15, 5
    v_lshl_or_b32 v162, v118, 16, v162
    s_mov_b64 exec, s[70:71]
    v_add_u32 v163, v163, v179
    v_and_b32 v118, 0x7fff, v131
    v_lshlrev_b32 v116, 1, v163
    ds_write_b16 v116, v118 offset:6528
    v_lshrrev_b32 v118, 20, v131
    v_lshlrev_b32 v116, 2, v163
    v_add_u32 v118, v118, v112
    ds_write_b32 v116, v118 offset:11008
    v_bfe_u32 v118, v131, 15, 5
    v_lshl_or_b32 v163, v118, 16, v163
    s_waitcnt lgkmcnt(4)
    s_mov_b64 exec, s[72:73]
    v_add_u32 v164, v164, v180
    v_and_b32 v118, 0x7fff, v132
    v_lshlrev_b32 v116, 1, v164
    ds_write_b16 v116, v118 offset:6528
    v_lshrrev_b32 v118, 20, v132
    v_lshlrev_b32 v116, 2, v164
    v_add_u32 v118, v118, v113
    ds_write_b32 v116, v118 offset:11008
    v_bfe_u32 v118, v132, 15, 5
    v_lshl_or_b32 v164, v118, 16, v164
    s_mov_b64 exec, s[74:75]
    v_add_u32 v165, v165, v181
    v_and_b32 v118, 0x7fff, v133
    v_lshlrev_b32 v116, 1, v165
    ds_write_b16 v116, v118 offset:6528
    v_lshrrev_b32 v118, 20, v133
    v_lshlrev_b32 v116, 2, v165
    v_add_u32 v118, v118, v113
    ds_write_b32 v116, v118 offset:11008
    v_bfe_u32 v118, v133, 15, 5
    v_lshl_or_b32 v165, v118, 16, v165
    s_mov_b64 exec, s[76:77]
    v_add_u32 v166, v166, v182
    v_and_b32 v118, 0x7fff, v134
    v_lshlrev_b32 v116, 1, v166
    ds_write_b16 v116, v118 offset:6528
    v_lshrrev_b32 v118, 20, v134
    v_lshlrev_b32 v116, 2, v166
    v_add_u32 v118, v118, v113
    ds_write_b32 v116, v118 offset:11008
    v_bfe_u32 v118, v134, 15, 5
    v_lshl_or_b32 v166, v118, 16, v166
    s_mov_b64 exec, s[78:79]
    v_add_u32 v167, v167, v183
    v_and_b32 v118, 0x7fff, v135
    v_lshlrev_b32 v116, 1, v167
    ds_write_b16 v116, v118 offset:6528
    v_lshrrev_b32 v118, 20, v135
    v_lshlrev_b32 v116, 2, v167
    v_add_u32 v118, v118, v113
    ds_write_b32 v116, v118 offset:11008
    v_bfe_u32 v118, v135, 15, 5
    v_lshl_or_b32 v167, v118, 16, v167
    s_waitcnt lgkmcnt(4)
    s_mov_b64 exec, -1
    s_cmp_eq_u32 s3, 0
    s_cbranch_scc1 L_k2_p2adone
    ds_bpermute_b32 v168, v168, v122
    ds_bpermute_b32 v169, v169, v122
    ds_bpermute_b32 v170, v170, v122
    ds_bpermute_b32 v171, v171, v122
    ds_bpermute_b32 v172, v172, v122
    ds_bpermute_b32 v173, v173, v122
    ds_bpermute_b32 v174, v174, v122
    ds_bpermute_b32 v175, v175, v122
    s_waitcnt lgkmcnt(0)
    v_subrev_u32 v115, 0x10101010, v104
    v_cmp_gt_i32 vcc, 0, v115
    s_mov_b64 exec, vcc
    v_add_u32 v168, v168, v184
    v_and_b32 v118, 0x7fff, v136
    v_lshlrev_b32 v116, 1, v168
    ds_write_b16 v116, v118 offset:6528
    v_lshrrev_b32 v118, 20, v136
    v_lshlrev_b32 v116, 2, v168
    v_add_u32 v118, v118, v112
    ds_write_b32 v116, v118 offset:11008
    v_bfe_u32 v118, v136, 15, 5
    v_lshl_or_b32 v168, v118, 16, v168
    s_mov_b64 exec, -1
    v_subrev_u32 v115, 0x11111111, v104
    v_cmp_gt_i32 vcc, 0, v115
    s_mov_b64 exec, vcc
    v_add_u32 v169, v169, v185
    v_and_b32 v118, 0x7fff, v137
    v_lshlrev_b32 v116, 1, v169
    ds_write_b16 v116, v118 offset:6528
    v_lshrrev_b32 v118, 20, v137
    v_lshlrev_b32 v116, 2, v169
    v_add_u32 v118, v118, v112
    ds_write_b32 v116, v118 offset:11008
    v_bfe_u32 v118, v137, 15, 5
    v_lshl_or_b32 v169, v118, 16, v169
    s_mov_b64 exec, -1
    v_subrev_u32 v115, 0x12121212, v104
    v_cmp_gt_i32 vcc, 0, v115
    s_mov_b64 exec, vcc
    v_add_u32 v170, v170, v186
    v_and_b32 v118, 0x7fff, v138
    v_lshlrev_b32 v116, 1, v170
    ds_write_b16 v116, v118 offset:6528
    v_lshrrev_b32 v118, 20, v138
    v_lshlrev_b32 v116, 2, v170
    v_add_u32 v118, v118, v112
    ds_write_b32 v116, v118 offset:11008
    v_bfe_u32 v118, v138, 15, 5
    v_lshl_or_b32 v170, v118, 16, v170
    s_mov_b64 exec, -1
    v_subrev_u32 v115, 0x13131313, v104
    v_cmp_gt_i32 vcc, 0, v115
    s_mov_b64 exec, vcc
    v_add_u32 v171, v171, v187
    v_and_b32 v118, 0x7fff, v139
    v_lshlrev_b32 v116, 1, v171
    ds_write_b16 v116, v118 offset:6528
    v_lshrrev_b32 v118, 20, v139
    v_lshlrev_b32 v116, 2, v171
    v_add_u32 v118, v118, v112
    ds_write_b32 v116, v118 offset:11008
    v_bfe_u32 v118, v139, 15, 5
    v_lshl_or_b32 v171, v118, 16, v171
    s_mov_b64 exec, -1
    s_waitcnt lgkmcnt(4)
    v_subrev_u32 v115, 0x10101010, v105
    v_cmp_gt_i32 vcc, 0, v115
    s_mov_b64 exec, vcc
    v_add_u32 v172, v172, v188
    v_and_b32 v118, 0x7fff, v140
    v_lshlrev_b32 v116, 1, v172
    ds_write_b16 v116, v118 offset:6528
    v_lshrrev_b32 v118, 20, v140
    v_lshlrev_b32 v116, 2, v172
    v_add_u32 v118, v118, v113
    ds_write_b32 v116, v118 offset:11008
    v_bfe_u32 v118, v140, 15, 5
    v_lshl_or_b32 v172, v118, 16, v172
    s_mov_b64 exec, -1
    v_subrev_u32 v115, 0x11111111, v105
    v_cmp_gt_i32 vcc, 0, v115
    s_mov_b64 exec, vcc
    v_add_u32 v173, v173, v189
    v_and_b32 v118, 0x7fff, v141
    v_lshlrev_b32 v116, 1, v173
    ds_write_b16 v116, v118 offset:6528
    v_lshrrev_b32 v118, 20, v141
    v_lshlrev_b32 v116, 2, v173
    v_add_u32 v118, v118, v113
    ds_write_b32 v116, v118 offset:11008
    v_bfe_u32 v118, v141, 15, 5
    v_lshl_or_b32 v173, v118, 16, v173
    s_mov_b64 exec, -1
    v_subrev_u32 v115, 0x12121212, v105
    v_cmp_gt_i32 vcc, 0, v115
    s_mov_b64 exec, vcc
    v_add_u32 v174, v174, v190
    v_and_b32 v118, 0x7fff, v142
    v_lshlrev_b32 v116, 1, v174
    ds_write_b16 v116, v118 offset:6528
    v_lshrrev_b32 v118, 20, v142
    v_lshlrev_b32 v116, 2, v174
    v_add_u32 v118, v118, v113
    ds_write_b32 v116, v118 offset:11008
    v_bfe_u32 v118, v142, 15, 5
    v_lshl_or_b32 v174, v118, 16, v174
    s_mov_b64 exec, -1
    v_subrev_u32 v115, 0x13131313, v105
    v_cmp_gt_i32 vcc, 0, v115
    s_mov_b64 exec, vcc
    v_add_u32 v175, v175, v191
    v_and_b32 v118, 0x7fff, v143
    v_lshlrev_b32 v116, 1, v175
    ds_write_b16 v116, v118 offset:6528
    v_lshrrev_b32 v118, 20, v143
    v_lshlrev_b32 v116, 2, v175
    v_add_u32 v118, v118, v113
    ds_write_b32 v116, v118 offset:11008
    v_bfe_u32 v118, v143, 15, 5
    v_lshl_or_b32 v175, v118, 16, v175
    s_mov_b64 exec, -1
    s_waitcnt lgkmcnt(4)
    s_mov_b64 exec, -1
L_k2_p2adone:
    s_waitcnt lgkmcnt(0)
    s_barrier
    ds_read_u16 v26, v20 offset:0
    ds_read_u16 v28, v20 offset:8
    ds_read_u16 v30, v20 offset:32
    ds_read_u16 v32, v20 offset:40
    ds_read_b32 v34, v19 offset:0
    s_waitcnt lgkmcnt(0)
    s_add_u32 m0, s85, 0
    s_add_u32 s91, s85, 1024
    buffer_load_dwordx4 v[34:35], s[20:23], 0 idxen offen  lds
    s_mov_b32 m0, s91
    s_nop 0
    buffer_load_dwordx4 v[26:27], s[48:51], 0 idxen offen lds
    buffer_load_dwordx4 v[28:29], s[52:55], 0 idxen offen offset:1024 lds
    buffer_load_dwordx4 v[30:31], s[56:59], 0 idxen offen offset:2048 lds
    buffer_load_dwordx4 v[32:33], s[60:63], 0 idxen offen offset:3072 lds
    ds_read_u16 v26, v20 offset:64
    ds_read_u16 v28, v20 offset:72
    ds_read_u16 v30, v20 offset:96
    ds_read_u16 v32, v20 offset:104
    ds_read_b32 v34, v19 offset:128
    s_waitcnt vmcnt(5)
    s_mov_b32 s4, 0xbfb8aa3b
    v_lshlrev_b32 v5, 16, v5
    v_lshlrev_b32 v6, 16, v6
    v_mul_f32 v5, s4, v5
    v_mul_f32 v6, s4, v6
    v_lshrrev_b32 v8, 1, v2
    v_xor_b32 v8, v8, v2
    v_and_b32 v8, 4, v8
    v_mul_u32_u24 v8, 3, v8
    v_xor_b32 v8, v8, v2
    v_lshrrev_b32 v7, 4, v8
    v_mul_u32_u24 v7, 15360, v7
    v_and_b32 v8, 15, v8
    v_xor_b32 v9, v8, v3
    v_lshlrev_b32 v9, 4, v9
    v_lshl_add_u32 v9, v8, 8, v9
    v_add_u32 v7, v7, v9
    s_mul_i32 s5, s45, 61440
    s_add_u32 s5, s5, 50432
    v_add_u32 v7, s5, v7
    v_lshlrev_b32 v146, 16, v146
    v_and_b32 v8, 127, v0
    v_lshlrev_b32 v8, 2, v8
    ds_write_b32 v8, v146 offset:5952
    v_xor_b32 v8, 0, v7
    ds_read_b128 v[128:131], v8 offset:0
    v_xor_b32 v9, 32, v7
    ds_read_b128 v[132:135], v9 offset:0
    v_xor_b32 v8, 64, v7
    ds_read_b128 v[136:139], v8 offset:0
    v_xor_b32 v9, 96, v7
    ds_read_b128 v[140:143], v9 offset:0
    v_xor_b32 v8, 128, v7
    ds_read_b128 v[144:147], v8 offset:0
    v_xor_b32 v9, 160, v7
    ds_read_b128 v[148:151], v9 offset:0
    v_xor_b32 v8, 192, v7
    ds_read_b128 v[152:155], v8 offset:0
    v_xor_b32 v9, 224, v7
    ds_read_b128 v[156:159], v9 offset:0
    s_mov_b64 exec, s[64:65]
    v_and_b32 v115, 0xffff, v160
    v_lshrrev_b32 v117, 16, v160
    v_and_b32 v116, -8, v115
    v_and_b32 v118, 30, v117
    ds_write_b8 v115, v117 offset:19968
    v_lshlrev_b32 v116, 3, v116
    v_lshl_add_u32 v116, v118, 1, v116
    v_and_b32 v118, 7, v115
    v_and_b32 v117, 1, v117
    v_lshl_add_u32 v118, v117, 4, v118
    v_lshlrev_b32 v118, v118, v120
    ds_or_b32 v116, v118 offset:22208
    s_mov_b64 exec, -1
    s_mov_b64 exec, s[66:67]
    v_and_b32 v115, 0xffff, v161
    v_lshrrev_b32 v117, 16, v161
    v_and_b32 v116, -8, v115
    v_and_b32 v118, 30, v117
    ds_write_b8 v115, v117 offset:19968
    v_lshlrev_b32 v116, 3, v116
    v_lshl_add_u32 v116, v118, 1, v116
    v_and_b32 v118, 7, v115
    v_and_b32 v117, 1, v117
    v_lshl_add_u32 v118, v117, 4, v118
    v_lshlrev_b32 v118, v118, v120
    ds_or_b32 v116, v118 offset:22208
    s_mov_b64 exec, -1
    s_waitcnt lgkmcnt(4)
    v_mfma_f32_32x32x16_bf16 v[176:191], v[128:131], v[192:195], 0
    v_mfma_f32_32x32x16_bf16 v[176:191], v[132:135], v[196:199], v[176:191]
    v_mfma_f32_32x32x16_bf16 v[176:191], v[136:139], v[200:203], v[176:191]
    v_mfma_f32_32x32x16_bf16 v[176:191], v[140:143], v[204:207], v[176:191]
    v_mfma_f32_32x32x16_bf16 v[176:191], v[144:147], v[208:211], v[176:191]
    v_mfma_f32_32x32x16_bf16 v[176:191], v[148:151], v[212:215], v[176:191]
    v_mfma_f32_32x32x16_bf16 v[176:191], v[152:155], v[216:219], v[176:191]
    v_mfma_f32_32x32x16_bf16 v[176:191], v[156:159], v[220:223], v[176:191]
    s_mov_b64 exec, s[68:69]
    v_and_b32 v115, 0xffff, v162
    v_lshrrev_b32 v117, 16, v162
    v_and_b32 v116, -8, v115
    v_and_b32 v118, 30, v117
    ds_write_b8 v115, v117 offset:19968
    v_lshlrev_b32 v116, 3, v116
    v_lshl_add_u32 v116, v118, 1, v116
    v_and_b32 v118, 7, v115
    v_and_b32 v117, 1, v117
    v_lshl_add_u32 v118, v117, 4, v118
    v_lshlrev_b32 v118, v118, v120
    ds_or_b32 v116, v118 offset:22208
    s_mov_b64 exec, -1
    v_mfma_f32_32x32x16_bf16 v[36:51], v[128:131], v[224:227], 0
    v_mfma_f32_32x32x16_bf16 v[36:51], v[132:135], v[228:231], v[36:51]
    v_mfma_f32_32x32x16_bf16 v[36:51], v[136:139], v[232:235], v[36:51]
    v_mfma_f32_32x32x16_bf16 v[36:51], v[140:143], v[236:239], v[36:51]
    v_mfma_f32_32x32x16_bf16 v[36:51], v[144:147], v[240:243], v[36:51]
    v_mfma_f32_32x32x16_bf16 v[36:51], v[148:151], v[244:247], v[36:51]
    v_mfma_f32_32x32x16_bf16 v[36:51], v[152:155], v[248:251], v[36:51]
    v_mfma_f32_32x32x16_bf16 v[36:51], v[156:159], v[252:255], v[36:51]
    s_add_u32 m0, s85, 5120
    s_add_u32 s91, s85, 6144
    buffer_load_dwordx4 v[34:35], s[20:23], 0 idxen offen  lds
    s_mov_b32 m0, s91
    s_nop 0
    buffer_load_dwordx4 v[26:27], s[48:51], 0 idxen offen lds
    buffer_load_dwordx4 v[28:29], s[52:55], 0 idxen offen offset:1024 lds
    buffer_load_dwordx4 v[30:31], s[56:59], 0 idxen offen offset:2048 lds
    buffer_load_dwordx4 v[32:33], s[60:63], 0 idxen offen offset:3072 lds
    ds_read_u16 v26, v20 offset:128
    ds_read_u16 v28, v20 offset:136
    ds_read_u16 v30, v20 offset:160
    ds_read_u16 v32, v20 offset:168
    ds_read_b32 v34, v19 offset:256
    v_xor_b32 v8, 0, v7
    ds_read_b128 v[128:131], v8 offset:30720
    v_xor_b32 v9, 32, v7
    ds_read_b128 v[132:135], v9 offset:30720
    v_xor_b32 v8, 64, v7
    ds_read_b128 v[136:139], v8 offset:30720
    v_xor_b32 v9, 96, v7
    ds_read_b128 v[140:143], v9 offset:30720
    v_xor_b32 v8, 128, v7
    ds_read_b128 v[144:147], v8 offset:30720
    v_xor_b32 v9, 160, v7
    ds_read_b128 v[148:151], v9 offset:30720
    v_xor_b32 v8, 192, v7
    ds_read_b128 v[152:155], v8 offset:30720
    v_xor_b32 v9, 224, v7
    ds_read_b128 v[156:159], v9 offset:30720
    s_mov_b64 exec, s[70:71]
    v_and_b32 v115, 0xffff, v163
    v_lshrrev_b32 v117, 16, v163
    v_and_b32 v116, -8, v115
    v_and_b32 v118, 30, v117
    ds_write_b8 v115, v117 offset:19968
    v_lshlrev_b32 v116, 3, v116
    v_lshl_add_u32 v116, v118, 1, v116
    v_and_b32 v118, 7, v115
    v_and_b32 v117, 1, v117
    v_lshl_add_u32 v118, v117, 4, v118
    v_lshlrev_b32 v118, v118, v120
    ds_or_b32 v116, v118 offset:22208
    s_mov_b64 exec, -1
    s_waitcnt lgkmcnt(8)
    v_fma_f32 v176, v176, s4, v5
    v_fma_f32 v177, v177, s4, v5
    v_fma_f32 v178, v178, s4, v5
    v_fma_f32 v179, v179, s4, v5
    v_fma_f32 v180, v180, s4, v5
    v_fma_f32 v181, v181, s4, v5
    v_fma_f32 v182, v182, s4, v5
    v_fma_f32 v183, v183, s4, v5
    v_fma_f32 v184, v184, s4, v5
    v_fma_f32 v185, v185, s4, v5
    v_fma_f32 v186, v186, s4, v5
    v_fma_f32 v187, v187, s4, v5
    v_fma_f32 v188, v188, s4, v5
    v_fma_f32 v189, v189, s4, v5
    v_fma_f32 v190, v190, s4, v5
    v_fma_f32 v191, v191, s4, v5
    v_cvt_pk_bf16_f32 v88, v176, v177
    v_cvt_pk_bf16_f32 v89, v178, v179
    v_cvt_pk_bf16_f32 v90, v180, v181
    v_cvt_pk_bf16_f32 v91, v182, v183
    v_cvt_pk_bf16_f32 v92, v184, v185
    v_cvt_pk_bf16_f32 v93, v186, v187
    v_cvt_pk_bf16_f32 v94, v188, v189
    v_cvt_pk_bf16_f32 v95, v190, v191
    s_mov_b64 exec, s[72:73]
    v_and_b32 v115, 0xffff, v164
    v_lshrrev_b32 v117, 16, v164
    v_and_b32 v116, -8, v115
    v_and_b32 v118, 30, v117
    ds_write_b8 v115, v117 offset:19968
    v_lshlrev_b32 v116, 3, v116
    v_lshl_add_u32 v116, v118, 1, v116
    v_and_b32 v118, 7, v115
    v_and_b32 v117, 1, v117
    v_lshl_add_u32 v118, v117, 4, v118
    v_lshlrev_b32 v118, v118, v120
    ds_or_b32 v116, v118 offset:22208
    s_mov_b64 exec, -1
    v_fma_f32 v36, v36, s4, v6
    v_fma_f32 v37, v37, s4, v6
    v_fma_f32 v38, v38, s4, v6
    v_fma_f32 v39, v39, s4, v6
    v_fma_f32 v40, v40, s4, v6
    v_fma_f32 v41, v41, s4, v6
    v_fma_f32 v42, v42, s4, v6
    v_fma_f32 v43, v43, s4, v6
    v_fma_f32 v44, v44, s4, v6
    v_fma_f32 v45, v45, s4, v6
    v_fma_f32 v46, v46, s4, v6
    v_fma_f32 v47, v47, s4, v6
    v_fma_f32 v48, v48, s4, v6
    v_fma_f32 v49, v49, s4, v6
    v_fma_f32 v50, v50, s4, v6
    v_fma_f32 v51, v51, s4, v6
    v_cvt_pk_bf16_f32 v96, v36, v37
    v_cvt_pk_bf16_f32 v97, v38, v39
    v_cvt_pk_bf16_f32 v98, v40, v41
    v_cvt_pk_bf16_f32 v99, v42, v43
    v_cvt_pk_bf16_f32 v100, v44, v45
    v_cvt_pk_bf16_f32 v101, v46, v47
    v_cvt_pk_bf16_f32 v102, v48, v49
    v_cvt_pk_bf16_f32 v103, v50, v51
    s_mov_b64 exec, s[74:75]
    v_and_b32 v115, 0xffff, v165
    v_lshrrev_b32 v117, 16, v165
    v_and_b32 v116, -8, v115
    v_and_b32 v118, 30, v117
    ds_write_b8 v115, v117 offset:19968
    v_lshlrev_b32 v116, 3, v116
    v_lshl_add_u32 v116, v118, 1, v116
    v_and_b32 v118, 7, v115
    v_and_b32 v117, 1, v117
    v_lshl_add_u32 v118, v117, 4, v118
    v_lshlrev_b32 v118, v118, v120
    ds_or_b32 v116, v118 offset:22208
    s_mov_b64 exec, -1
    s_waitcnt lgkmcnt(2)
    v_mfma_f32_32x32x16_bf16 v[176:191], v[128:131], v[192:195], 0
    v_mfma_f32_32x32x16_bf16 v[176:191], v[132:135], v[196:199], v[176:191]
    v_mfma_f32_32x32x16_bf16 v[176:191], v[136:139], v[200:203], v[176:191]
    v_mfma_f32_32x32x16_bf16 v[176:191], v[140:143], v[204:207], v[176:191]
    v_mfma_f32_32x32x16_bf16 v[176:191], v[144:147], v[208:211], v[176:191]
    v_mfma_f32_32x32x16_bf16 v[176:191], v[148:151], v[212:215], v[176:191]
    v_mfma_f32_32x32x16_bf16 v[176:191], v[152:155], v[216:219], v[176:191]
    v_mfma_f32_32x32x16_bf16 v[176:191], v[156:159], v[220:223], v[176:191]
    s_mov_b64 exec, s[76:77]
    v_and_b32 v115, 0xffff, v166
    v_lshrrev_b32 v117, 16, v166
    v_and_b32 v116, -8, v115
    v_and_b32 v118, 30, v117
    ds_write_b8 v115, v117 offset:19968
    v_lshlrev_b32 v116, 3, v116
    v_lshl_add_u32 v116, v118, 1, v116
    v_and_b32 v118, 7, v115
    v_and_b32 v117, 1, v117
    v_lshl_add_u32 v118, v117, 4, v118
    v_lshlrev_b32 v118, v118, v120
    ds_or_b32 v116, v118 offset:22208
    s_mov_b64 exec, -1
    v_mfma_f32_32x32x16_bf16 v[36:51], v[128:131], v[224:227], 0
    v_mfma_f32_32x32x16_bf16 v[36:51], v[132:135], v[228:231], v[36:51]
    v_mfma_f32_32x32x16_bf16 v[36:51], v[136:139], v[232:235], v[36:51]
    v_mfma_f32_32x32x16_bf16 v[36:51], v[140:143], v[236:239], v[36:51]
    v_mfma_f32_32x32x16_bf16 v[36:51], v[144:147], v[240:243], v[36:51]
    v_mfma_f32_32x32x16_bf16 v[36:51], v[148:151], v[244:247], v[36:51]
    v_mfma_f32_32x32x16_bf16 v[36:51], v[152:155], v[248:251], v[36:51]
    v_mfma_f32_32x32x16_bf16 v[36:51], v[156:159], v[252:255], v[36:51]
    s_mov_b64 exec, s[78:79]
    v_and_b32 v115, 0xffff, v167
    v_lshrrev_b32 v117, 16, v167
    v_and_b32 v116, -8, v115
    v_and_b32 v118, 30, v117
    ds_write_b8 v115, v117 offset:19968
    v_lshlrev_b32 v116, 3, v116
    v_lshl_add_u32 v116, v118, 1, v116
    v_and_b32 v118, 7, v115
    v_and_b32 v117, 1, v117
    v_lshl_add_u32 v118, v117, 4, v118
    v_lshlrev_b32 v118, v118, v120
    ds_or_b32 v116, v118 offset:22208
    s_mov_b64 exec, -1
    s_cmp_eq_u32 s3, 0
    s_cbranch_scc1 L_k2_p2done
    v_subrev_u32 v115, 0x10101010, v104
    v_cmp_gt_i32 vcc, 0, v115
    s_mov_b64 exec, vcc
    v_and_b32 v115, 0xffff, v168
    v_lshrrev_b32 v117, 16, v168
    v_and_b32 v116, -8, v115
    v_and_b32 v118, 30, v117
    ds_write_b8 v115, v117 offset:19968
    v_lshlrev_b32 v116, 3, v116
    v_lshl_add_u32 v116, v118, 1, v116
    v_and_b32 v118, 7, v115
    v_and_b32 v117, 1, v117
    v_lshl_add_u32 v118, v117, 4, v118
    v_lshlrev_b32 v118, v118, v120
    ds_or_b32 v116, v118 offset:22208
    s_mov_b64 exec, -1
    v_subrev_u32 v115, 0x11111111, v104
    v_cmp_gt_i32 vcc, 0, v115
    s_mov_b64 exec, vcc
    v_and_b32 v115, 0xffff, v169
    v_lshrrev_b32 v117, 16, v169
    v_and_b32 v116, -8, v115
    v_and_b32 v118, 30, v117
    ds_write_b8 v115, v117 offset:19968
    v_lshlrev_b32 v116, 3, v116
    v_lshl_add_u32 v116, v118, 1, v116
    v_and_b32 v118, 7, v115
    v_and_b32 v117, 1, v117
    v_lshl_add_u32 v118, v117, 4, v118
    v_lshlrev_b32 v118, v118, v120
    ds_or_b32 v116, v118 offset:22208
    s_mov_b64 exec, -1
    v_subrev_u32 v115, 0x12121212, v104
    v_cmp_gt_i32 vcc, 0, v115
    s_mov_b64 exec, vcc
    v_and_b32 v115, 0xffff, v170
    v_lshrrev_b32 v117, 16, v170
    v_and_b32 v116, -8, v115
    v_and_b32 v118, 30, v117
    ds_write_b8 v115, v117 offset:19968
    v_lshlrev_b32 v116, 3, v116
    v_lshl_add_u32 v116, v118, 1, v116
    v_and_b32 v118, 7, v115
    v_and_b32 v117, 1, v117
    v_lshl_add_u32 v118, v117, 4, v118
    v_lshlrev_b32 v118, v118, v120
    ds_or_b32 v116, v118 offset:22208
    s_mov_b64 exec, -1
    v_subrev_u32 v115, 0x13131313, v104
    v_cmp_gt_i32 vcc, 0, v115
    s_mov_b64 exec, vcc
    v_and_b32 v115, 0xffff, v171
    v_lshrrev_b32 v117, 16, v171
    v_and_b32 v116, -8, v115
    v_and_b32 v118, 30, v117
    ds_write_b8 v115, v117 offset:19968
    v_lshlrev_b32 v116, 3, v116
    v_lshl_add_u32 v116, v118, 1, v116
    v_and_b32 v118, 7, v115
    v_and_b32 v117, 1, v117
    v_lshl_add_u32 v118, v117, 4, v118
    v_lshlrev_b32 v118, v118, v120
    ds_or_b32 v116, v118 offset:22208
    s_mov_b64 exec, -1
    s_waitcnt lgkmcnt(4)
    v_subrev_u32 v115, 0x10101010, v105
    v_cmp_gt_i32 vcc, 0, v115
    s_mov_b64 exec, vcc
    v_and_b32 v115, 0xffff, v172
    v_lshrrev_b32 v117, 16, v172
    v_and_b32 v116, -8, v115
    v_and_b32 v118, 30, v117
    ds_write_b8 v115, v117 offset:19968
    v_lshlrev_b32 v116, 3, v116
    v_lshl_add_u32 v116, v118, 1, v116
    v_and_b32 v118, 7, v115
    v_and_b32 v117, 1, v117
    v_lshl_add_u32 v118, v117, 4, v118
    v_lshlrev_b32 v118, v118, v120
    ds_or_b32 v116, v118 offset:22208
    s_mov_b64 exec, -1
    v_subrev_u32 v115, 0x11111111, v105
    v_cmp_gt_i32 vcc, 0, v115
    s_mov_b64 exec, vcc
    v_and_b32 v115, 0xffff, v173
    v_lshrrev_b32 v117, 16, v173
    v_and_b32 v116, -8, v115
    v_and_b32 v118, 30, v117
    ds_write_b8 v115, v117 offset:19968
    v_lshlrev_b32 v116, 3, v116
    v_lshl_add_u32 v116, v118, 1, v116
    v_and_b32 v118, 7, v115
    v_and_b32 v117, 1, v117
    v_lshl_add_u32 v118, v117, 4, v118
    v_lshlrev_b32 v118, v118, v120
    ds_or_b32 v116, v118 offset:22208
    s_mov_b64 exec, -1
    v_subrev_u32 v115, 0x12121212, v105
    v_cmp_gt_i32 vcc, 0, v115
    s_mov_b64 exec, vcc
    v_and_b32 v115, 0xffff, v174
    v_lshrrev_b32 v117, 16, v174
    v_and_b32 v116, -8, v115
    v_and_b32 v118, 30, v117
    ds_write_b8 v115, v117 offset:19968
    v_lshlrev_b32 v116, 3, v116
    v_lshl_add_u32 v116, v118, 1, v116
    v_and_b32 v118, 7, v115
    v_and_b32 v117, 1, v117
    v_lshl_add_u32 v118, v117, 4, v118
    v_lshlrev_b32 v118, v118, v120
    ds_or_b32 v116, v118 offset:22208
    s_mov_b64 exec, -1
    v_subrev_u32 v115, 0x13131313, v105
    v_cmp_gt_i32 vcc, 0, v115
    s_mov_b64 exec, vcc
    v_and_b32 v115, 0xffff, v175
    v_lshrrev_b32 v117, 16, v175
    v_and_b32 v116, -8, v115
    v_and_b32 v118, 30, v117
    ds_write_b8 v115, v117 offset:19968
    v_lshlrev_b32 v116, 3, v116
    v_lshl_add_u32 v116, v118, 1, v116
    v_and_b32 v118, 7, v115
    v_and_b32 v117, 1, v117
    v_lshl_add_u32 v118, v117, 4, v118
    v_lshlrev_b32 v118, v118, v120
    ds_or_b32 v116, v118 offset:22208
    s_mov_b64 exec, -1
    s_waitcnt lgkmcnt(4)
L_k2_p2done:
    s_nop 7
    v_fma_f32 v176, v176, s4, v5
    v_fma_f32 v177, v177, s4, v5
    v_fma_f32 v178, v178, s4, v5
    v_fma_f32 v179, v179, s4, v5
    v_fma_f32 v180, v180, s4, v5
    v_fma_f32 v181, v181, s4, v5
    v_fma_f32 v182, v182, s4, v5
    v_fma_f32 v183, v183, s4, v5
    v_fma_f32 v184, v184, s4, v5
    v_fma_f32 v185, v185, s4, v5
    v_fma_f32 v186, v186, s4, v5
    v_fma_f32 v187, v187, s4, v5
    v_fma_f32 v188, v188, s4, v5
    v_fma_f32 v189, v189, s4, v5
    v_fma_f32 v190, v190, s4, v5
    v_fma_f32 v191, v191, s4, v5
    v_cvt_pk_bf16_f32 v224, v176, v177
    v_cvt_pk_bf16_f32 v225, v178, v179
    v_cvt_pk_bf16_f32 v226, v180, v181
    v_cvt_pk_bf16_f32 v227, v182, v183
    v_cvt_pk_bf16_f32 v228, v184, v185
    v_cvt_pk_bf16_f32 v229, v186, v187
    v_cvt_pk_bf16_f32 v230, v188, v189
    v_cvt_pk_bf16_f32 v231, v190, v191
    v_fma_f32 v36, v36, s4, v6
    v_fma_f32 v37, v37, s4, v6
    v_fma_f32 v38, v38, s4, v6
    v_fma_f32 v39, v39, s4, v6
    v_fma_f32 v40, v40, s4, v6
    v_fma_f32 v41, v41, s4, v6
    v_fma_f32 v42, v42, s4, v6
    v_fma_f32 v43, v43, s4, v6
    v_fma_f32 v44, v44, s4, v6
    v_fma_f32 v45, v45, s4, v6
    v_fma_f32 v46, v46, s4, v6
    v_fma_f32 v47, v47, s4, v6
    v_fma_f32 v48, v48, s4, v6
    v_fma_f32 v49, v49, s4, v6
    v_fma_f32 v50, v50, s4, v6
    v_fma_f32 v51, v51, s4, v6
    v_cvt_pk_bf16_f32 v232, v36, v37
    v_cvt_pk_bf16_f32 v233, v38, v39
    v_cvt_pk_bf16_f32 v234, v40, v41
    v_cvt_pk_bf16_f32 v235, v42, v43
    v_cvt_pk_bf16_f32 v236, v44, v45
    v_cvt_pk_bf16_f32 v237, v46, v47
    v_cvt_pk_bf16_f32 v238, v48, v49
    v_cvt_pk_bf16_f32 v239, v50, v51
    s_waitcnt lgkmcnt(0)
    s_barrier
    ds_read_u8 v13, v18
    v_mov_b64 v[160:161], 0
    v_mov_b64 v[162:163], 0
    v_mov_b64 v[164:165], 0
    v_mov_b64 v[166:167], 0
    v_mov_b64 v[168:169], 0
    v_mov_b64 v[170:171], 0
    v_mov_b64 v[172:173], 0
    v_mov_b64 v[174:175], 0
    v_mov_b64 v[176:177], 0
    v_mov_b64 v[178:179], 0
    v_mov_b64 v[180:181], 0
    v_mov_b64 v[182:183], 0
    v_mov_b64 v[184:185], 0
    v_mov_b64 v[186:187], 0
    v_mov_b64 v[188:189], 0
    v_mov_b64 v[190:191], 0
    v_mov_b64 v[104:105], 0
    v_mov_b64 v[36:37], 0
    v_mov_b64 v[106:107], 0
    v_mov_b64 v[38:39], 0
    v_mov_b64 v[108:109], 0
    v_mov_b64 v[40:41], 0
    v_mov_b64 v[110:111], 0
    v_mov_b64 v[42:43], 0
    s_waitcnt vmcnt(5)
    ds_read_b128 v[64:67], v22
    ds_read_b128 v[68:71], v23
    ds_read_b128 v[56:59], v24
    ds_read_b128 v[60:63], v25
    ds_read_b128 v[52:55], v21
    s_waitcnt lgkmcnt(0)
    v_lshl_add_u32 v15, v13, 4, v12
    ds_read_b128 v[44:47], v15 offset:256
    ds_read_b128 v[48:51], v15
    s_waitcnt lgkmcnt(0)
    v_mfma_f32_32x32x16_bf16 v[128:143], v[52:55], v[80:83], 0
    v_mfma_f32_32x32x16_bf16 v[128:143], v[44:47], v[88:91], v[128:143]
    v_mfma_f32_32x32x16_bf16 v[128:143], v[48:51], v[92:95], v[128:143]
    v_mfma_f32_32x32x16_bf16 v[128:143], v[64:67], v[72:75], v[128:143]
    v_mfma_f32_32x32x16_bf16 v[128:143], v[68:71], v[76:79], v[128:143]
    s_add_u32 m0, s85, 10240
    s_add_u32 s91, s85, 11264
    buffer_load_dwordx4 v[34:35], s[20:23], 0 idxen offen  lds
    s_mov_b32 m0, s91
    s_nop 0
    buffer_load_dwordx4 v[26:27], s[48:51], 0 idxen offen lds
    buffer_load_dwordx4 v[28:29], s[52:55], 0 idxen offen offset:1024 lds
    buffer_load_dwordx4 v[30:31], s[56:59], 0 idxen offen offset:2048 lds
    buffer_load_dwordx4 v[32:33], s[60:63], 0 idxen offen offset:3072 lds
    s_mov_b32 s80, 0
    s_mov_b32 s81, s83
    s_mov_b32 s82, 0
    s_mov_b32 s47, 0
    s_cmp_eq_u32 s80, s81
    s_cbranch_scc1 L_k2_switch
    s_branch L_k2_enter
L_k2_begin:
    s_cmp_eq_u32 s80, s81
    s_cbranch_scc1 L_k2_switch
    v_mfma_f32_32x32x16_bf16 v[128:143], v[52:55], v[80:83], 0
    v_mfma_f32_32x32x16_bf16 v[128:143], v[44:47], v[88:91], v[128:143]
    v_mfma_f32_32x32x16_bf16 v[128:143], v[48:51], v[92:95], v[128:143]
    v_mfma_f32_32x32x16_bf16 v[128:143], v[64:67], v[72:75], v[128:143]
    v_mfma_f32_32x32x16_bf16 v[128:143], v[68:71], v[76:79], v[128:143]
    s_nop 15
L_k2_enter:
    s_cmp_eq_u32 s45, 1
    s_cbranch_scc1 L_k2_t1
    s_setprio 0
    s_cmp_eq_u32 s47, 1
    s_cbranch_scc1 L_k2_t0b1
    s_cmp_eq_u32 s47, 2
    s_cbranch_scc1 L_k2_t0b2
.p2align 6
L_k2_t0b0:
    s_waitcnt vmcnt(5)
    ds_read_b128 v[64:67], v22 offset:5120
    ds_read_b128 v[68:71], v23 offset:5120
    ds_read_u16 v16, v14 offset:0
    ds_read_u16 v17, v14 offset:128
    ds_read_u8 v13, v18 offset:32
    ds_read_u16 v26, v20 offset:192
    ds_read_u16 v28, v20 offset:200
    ds_read_u16 v30, v20 offset:224
    ds_read_u16 v32, v20 offset:232
    ds_read_b32 v34, v19 offset:384
    v_mfma_f32_32x32x16_bf16 v[176:191], v[104:107], v[36:39], v[176:191]
    v_exp_f32 v112, v128
    v_exp_f32 v113, v129
    v_exp_f32 v114, v130
    v_mfma_f32_32x32x16_bf16 v[176:191], v[108:111], v[40:43], v[176:191]
    v_exp_f32 v115, v131
    v_exp_f32 v116, v132
    v_exp_f32 v117, v133
    v_mfma_f32_32x32x16_bf16 v[144:159], v[52:55], v[84:87], 0
    v_exp_f32 v118, v134
    v_exp_f32 v119, v135
    v_exp_f32 v120, v136
    v_mfma_f32_32x32x16_bf16 v[144:159], v[44:47], v[96:99], v[144:159]
    v_exp_f32 v121, v137
    v_exp_f32 v122, v138
    v_exp_f32 v123, v139
    v_exp_f32 v124, v140
    v_exp_f32 v125, v141
    v_exp_f32 v126, v142
    v_exp_f32 v127, v143
    v_pk_add_f32 v[112:113], v[112:113], s[86:87]
    v_pk_add_f32 v[114:115], v[114:115], s[86:87]
    v_pk_add_f32 v[116:117], v[116:117], s[86:87]
    v_pk_add_f32 v[118:119], v[118:119], s[86:87]
    v_pk_add_f32 v[120:121], v[120:121], s[86:87]
    v_pk_add_f32 v[122:123], v[122:123], s[86:87]
    v_pk_add_f32 v[124:125], v[124:125], s[86:87]
    v_pk_add_f32 v[126:127], v[126:127], s[86:87]
    v_mfma_f32_32x32x16_bf16 v[144:159], v[48:51], v[100:103], v[144:159]
    v_rcp_f32 v112, v112
    v_rcp_f32 v113, v113
    s_waitcnt lgkmcnt(0)
    v_lshl_add_u32 v15, v13, 4, v12
    ds_read_b128 v[36:39], v16 offset:1024
    ds_read_b128 v[40:43], v17 offset:1024
    ds_read_b128 v[52:55], v21 offset:5120
    ds_read_b128 v[44:47], v15 offset:256
    ds_read_b128 v[48:51], v15
    v_rcp_f32 v114, v114
    v_mfma_f32_32x32x16_bf16 v[144:159], v[56:59], v[72:75], v[144:159]
    v_rcp_f32 v115, v115
    v_rcp_f32 v116, v116
    v_rcp_f32 v117, v117
    v_mfma_f32_32x32x16_bf16 v[144:159], v[60:63], v[76:79], v[144:159]
    v_rcp_f32 v118, v118
    v_rcp_f32 v119, v119
    v_rcp_f32 v120, v120
    v_rcp_f32 v121, v121
    v_rcp_f32 v122, v122
    v_rcp_f32 v123, v123
    v_rcp_f32 v124, v124
    v_rcp_f32 v125, v125
    v_rcp_f32 v126, v126
    v_rcp_f32 v127, v127
    v_pk_mul_f32 v[112:113], v[128:129], v[112:113]
    v_pk_mul_f32 v[114:115], v[130:131], v[114:115]
    v_pk_mul_f32 v[116:117], v[132:133], v[116:117]
    v_pk_mul_f32 v[118:119], v[134:135], v[118:119]
    v_pk_mul_f32 v[120:121], v[136:137], v[120:121]
    v_pk_mul_f32 v[122:123], v[138:139], v[122:123]
    v_pk_mul_f32 v[124:125], v[140:141], v[124:125]
    v_pk_mul_f32 v[126:127], v[142:143], v[126:127]
    v_cvt_pk_bf16_f32 v104, v112, v113
    v_cvt_pk_bf16_f32 v105, v114, v115
    v_cvt_pk_bf16_f32 v106, v116, v117
    v_cvt_pk_bf16_f32 v107, v118, v119
    v_cvt_pk_bf16_f32 v108, v120, v121
    v_cvt_pk_bf16_f32 v109, v122, v123
    v_cvt_pk_bf16_f32 v110, v124, v125
    v_cvt_pk_bf16_f32 v111, v126, v127
    s_waitcnt lgkmcnt(0)
    ds_read_b128 v[56:59], v24 offset:5120
    ds_read_b128 v[60:63], v25 offset:5120
    v_mfma_f32_32x32x16_bf16 v[160:175], v[104:107], v[36:39], v[160:175]
    v_exp_f32 v112, v144
    v_exp_f32 v113, v145
    v_exp_f32 v114, v146
    v_mfma_f32_32x32x16_bf16 v[160:175], v[108:111], v[40:43], v[160:175]
    v_exp_f32 v115, v147
    v_exp_f32 v116, v148
    v_exp_f32 v117, v149
    v_mfma_f32_32x32x16_bf16 v[128:143], v[52:55], v[80:83], 0
    v_exp_f32 v118, v150
    v_exp_f32 v119, v151
    v_exp_f32 v120, v152
    v_mfma_f32_32x32x16_bf16 v[128:143], v[44:47], v[88:91], v[128:143]
    v_exp_f32 v121, v153
    v_exp_f32 v122, v154
    v_exp_f32 v123, v155
    s_add_u32 m0, s85, 0
    s_add_u32 s91, s85, 1024
    buffer_load_dwordx4 v[34:35], s[20:23], 0 idxen offen  lds
    s_mov_b32 m0, s91
    s_nop 0
    buffer_load_dwordx4 v[26:27], s[48:51], 0 idxen offen lds
    buffer_load_dwordx4 v[28:29], s[52:55], 0 idxen offen offset:1024 lds
    buffer_load_dwordx4 v[30:31], s[56:59], 0 idxen offen offset:2048 lds
    buffer_load_dwordx4 v[32:33], s[60:63], 0 idxen offen offset:3072 lds
    v_exp_f32 v124, v156
    v_exp_f32 v125, v157
    v_exp_f32 v126, v158
    v_exp_f32 v127, v159
    v_pk_add_f32 v[112:113], v[112:113], s[86:87]
    v_pk_add_f32 v[114:115], v[114:115], s[86:87]
    v_pk_add_f32 v[116:117], v[116:117], s[86:87]
    v_pk_add_f32 v[118:119], v[118:119], s[86:87]
    v_pk_add_f32 v[120:121], v[120:121], s[86:87]
    v_pk_add_f32 v[122:123], v[122:123], s[86:87]
    v_pk_add_f32 v[124:125], v[124:125], s[86:87]
    v_pk_add_f32 v[126:127], v[126:127], s[86:87]
    v_mfma_f32_32x32x16_bf16 v[128:143], v[48:51], v[92:95], v[128:143]
    v_rcp_f32 v112, v112
    v_rcp_f32 v113, v113
    v_rcp_f32 v114, v114
    v_mfma_f32_32x32x16_bf16 v[128:143], v[64:67], v[72:75], v[128:143]
    v_rcp_f32 v115, v115
    v_rcp_f32 v116, v116
    v_rcp_f32 v117, v117
    v_mfma_f32_32x32x16_bf16 v[128:143], v[68:71], v[76:79], v[128:143]
    v_rcp_f32 v118, v118
    v_rcp_f32 v119, v119
    v_rcp_f32 v120, v120
    v_rcp_f32 v121, v121
    v_rcp_f32 v122, v122
    v_rcp_f32 v123, v123
    v_rcp_f32 v124, v124
    v_rcp_f32 v125, v125
    v_rcp_f32 v126, v126
    v_rcp_f32 v127, v127
    v_pk_mul_f32 v[112:113], v[144:145], v[112:113]
    v_pk_mul_f32 v[114:115], v[146:147], v[114:115]
    v_pk_mul_f32 v[116:117], v[148:149], v[116:117]
    v_pk_mul_f32 v[118:119], v[150:151], v[118:119]
    v_pk_mul_f32 v[120:121], v[152:153], v[120:121]
    v_pk_mul_f32 v[122:123], v[154:155], v[122:123]
    v_pk_mul_f32 v[124:125], v[156:157], v[124:125]
    v_pk_mul_f32 v[126:127], v[158:159], v[126:127]
    v_cvt_pk_bf16_f32 v104, v112, v113
    v_cvt_pk_bf16_f32 v105, v114, v115
    v_cvt_pk_bf16_f32 v106, v116, v117
    v_cvt_pk_bf16_f32 v107, v118, v119
    v_cvt_pk_bf16_f32 v108, v120, v121
    v_cvt_pk_bf16_f32 v109, v122, v123
    v_cvt_pk_bf16_f32 v110, v124, v125
    v_cvt_pk_bf16_f32 v111, v126, v127
    s_mov_b32 s47, 1
    s_add_u32 s80, s80, 1
    s_cmp_eq_u32 s80, s81
    s_cbranch_scc1 L_k2_switch
L_k2_t0b1:
    s_waitcnt vmcnt(5)
    ds_read_b128 v[64:67], v22 offset:10240
    ds_read_b128 v[68:71], v23 offset:10240
    ds_read_u16 v16, v14 offset:256
    ds_read_u16 v17, v14 offset:384
    ds_read_u8 v13, v18 offset:64
    ds_read_u16 v26, v20 offset:256
    ds_read_u16 v28, v20 offset:264
    ds_read_u16 v30, v20 offset:288
    ds_read_u16 v32, v20 offset:296
    ds_read_b32 v34, v19 offset:512
    v_mfma_f32_32x32x16_bf16 v[176:191], v[104:107], v[36:39], v[176:191]
    v_exp_f32 v112, v128
    v_exp_f32 v113, v129
    v_exp_f32 v114, v130
    v_mfma_f32_32x32x16_bf16 v[176:191], v[108:111], v[40:43], v[176:191]
    v_exp_f32 v115, v131
    v_exp_f32 v116, v132
    v_exp_f32 v117, v133
    v_mfma_f32_32x32x16_bf16 v[144:159], v[52:55], v[84:87], 0
    v_exp_f32 v118, v134
    v_exp_f32 v119, v135
    v_exp_f32 v120, v136
    v_mfma_f32_32x32x16_bf16 v[144:159], v[44:47], v[96:99], v[144:159]
    v_exp_f32 v121, v137
    v_exp_f32 v122, v138
    v_exp_f32 v123, v139
    v_exp_f32 v124, v140
    v_exp_f32 v125, v141
    v_exp_f32 v126, v142
    v_exp_f32 v127, v143
    v_pk_add_f32 v[112:113], v[112:113], s[86:87]
    v_pk_add_f32 v[114:115], v[114:115], s[86:87]
    v_pk_add_f32 v[116:117], v[116:117], s[86:87]
    v_pk_add_f32 v[118:119], v[118:119], s[86:87]
    v_pk_add_f32 v[120:121], v[120:121], s[86:87]
    v_pk_add_f32 v[122:123], v[122:123], s[86:87]
    v_pk_add_f32 v[124:125], v[124:125], s[86:87]
    v_pk_add_f32 v[126:127], v[126:127], s[86:87]
    v_mfma_f32_32x32x16_bf16 v[144:159], v[48:51], v[100:103], v[144:159]
    v_rcp_f32 v112, v112
    v_rcp_f32 v113, v113
    s_waitcnt lgkmcnt(0)
    v_lshl_add_u32 v15, v13, 4, v12
    ds_read_b128 v[36:39], v16 offset:1024
    ds_read_b128 v[40:43], v17 offset:1024
    ds_read_b128 v[52:55], v21 offset:10240
    ds_read_b128 v[44:47], v15 offset:256
    ds_read_b128 v[48:51], v15
    v_rcp_f32 v114, v114
    v_mfma_f32_32x32x16_bf16 v[144:159], v[56:59], v[72:75], v[144:159]
    v_rcp_f32 v115, v115
    v_rcp_f32 v116, v116
    v_rcp_f32 v117, v117
    v_mfma_f32_32x32x16_bf16 v[144:159], v[60:63], v[76:79], v[144:159]
    v_rcp_f32 v118, v118
    v_rcp_f32 v119, v119
    v_rcp_f32 v120, v120
    v_rcp_f32 v121, v121
    v_rcp_f32 v122, v122
    v_rcp_f32 v123, v123
    v_rcp_f32 v124, v124
    v_rcp_f32 v125, v125
    v_rcp_f32 v126, v126
    v_rcp_f32 v127, v127
    v_pk_mul_f32 v[112:113], v[128:129], v[112:113]
    v_pk_mul_f32 v[114:115], v[130:131], v[114:115]
    v_pk_mul_f32 v[116:117], v[132:133], v[116:117]
    v_pk_mul_f32 v[118:119], v[134:135], v[118:119]
    v_pk_mul_f32 v[120:121], v[136:137], v[120:121]
    v_pk_mul_f32 v[122:123], v[138:139], v[122:123]
    v_pk_mul_f32 v[124:125], v[140:141], v[124:125]
    v_pk_mul_f32 v[126:127], v[142:143], v[126:127]
    v_cvt_pk_bf16_f32 v104, v112, v113
    v_cvt_pk_bf16_f32 v105, v114, v115
    v_cvt_pk_bf16_f32 v106, v116, v117
    v_cvt_pk_bf16_f32 v107, v118, v119
    v_cvt_pk_bf16_f32 v108, v120, v121
    v_cvt_pk_bf16_f32 v109, v122, v123
    v_cvt_pk_bf16_f32 v110, v124, v125
    v_cvt_pk_bf16_f32 v111, v126, v127
    s_waitcnt lgkmcnt(0)
    ds_read_b128 v[56:59], v24 offset:10240
    ds_read_b128 v[60:63], v25 offset:10240
    v_mfma_f32_32x32x16_bf16 v[160:175], v[104:107], v[36:39], v[160:175]
    v_exp_f32 v112, v144
    v_exp_f32 v113, v145
    v_exp_f32 v114, v146
    v_mfma_f32_32x32x16_bf16 v[160:175], v[108:111], v[40:43], v[160:175]
    v_exp_f32 v115, v147
    v_exp_f32 v116, v148
    v_exp_f32 v117, v149
    v_mfma_f32_32x32x16_bf16 v[128:143], v[52:55], v[80:83], 0
    v_exp_f32 v118, v150
    v_exp_f32 v119, v151
    v_exp_f32 v120, v152
    v_mfma_f32_32x32x16_bf16 v[128:143], v[44:47], v[88:91], v[128:143]
    v_exp_f32 v121, v153
    v_exp_f32 v122, v154
    v_exp_f32 v123, v155
    s_add_u32 m0, s85, 5120
    s_add_u32 s91, s85, 6144
    buffer_load_dwordx4 v[34:35], s[20:23], 0 idxen offen  lds
    s_mov_b32 m0, s91
    s_nop 0
    buffer_load_dwordx4 v[26:27], s[48:51], 0 idxen offen lds
    buffer_load_dwordx4 v[28:29], s[52:55], 0 idxen offen offset:1024 lds
    buffer_load_dwordx4 v[30:31], s[56:59], 0 idxen offen offset:2048 lds
    buffer_load_dwordx4 v[32:33], s[60:63], 0 idxen offen offset:3072 lds
    v_exp_f32 v124, v156
    v_exp_f32 v125, v157
    v_exp_f32 v126, v158
    v_exp_f32 v127, v159
    v_pk_add_f32 v[112:113], v[112:113], s[86:87]
    v_pk_add_f32 v[114:115], v[114:115], s[86:87]
    v_pk_add_f32 v[116:117], v[116:117], s[86:87]
    v_pk_add_f32 v[118:119], v[118:119], s[86:87]
    v_pk_add_f32 v[120:121], v[120:121], s[86:87]
    v_pk_add_f32 v[122:123], v[122:123], s[86:87]
    v_pk_add_f32 v[124:125], v[124:125], s[86:87]
    v_pk_add_f32 v[126:127], v[126:127], s[86:87]
    v_mfma_f32_32x32x16_bf16 v[128:143], v[48:51], v[92:95], v[128:143]
    v_rcp_f32 v112, v112
    v_rcp_f32 v113, v113
    v_rcp_f32 v114, v114
    v_mfma_f32_32x32x16_bf16 v[128:143], v[64:67], v[72:75], v[128:143]
    v_rcp_f32 v115, v115
    v_rcp_f32 v116, v116
    v_rcp_f32 v117, v117
    v_mfma_f32_32x32x16_bf16 v[128:143], v[68:71], v[76:79], v[128:143]
    v_rcp_f32 v118, v118
    v_rcp_f32 v119, v119
    v_rcp_f32 v120, v120
    v_rcp_f32 v121, v121
    v_rcp_f32 v122, v122
    v_rcp_f32 v123, v123
    v_rcp_f32 v124, v124
    v_rcp_f32 v125, v125
    v_rcp_f32 v126, v126
    v_rcp_f32 v127, v127
    v_pk_mul_f32 v[112:113], v[144:145], v[112:113]
    v_pk_mul_f32 v[114:115], v[146:147], v[114:115]
    v_pk_mul_f32 v[116:117], v[148:149], v[116:117]
    v_pk_mul_f32 v[118:119], v[150:151], v[118:119]
    v_pk_mul_f32 v[120:121], v[152:153], v[120:121]
    v_pk_mul_f32 v[122:123], v[154:155], v[122:123]
    v_pk_mul_f32 v[124:125], v[156:157], v[124:125]
    v_pk_mul_f32 v[126:127], v[158:159], v[126:127]
    v_cvt_pk_bf16_f32 v104, v112, v113
    v_cvt_pk_bf16_f32 v105, v114, v115
    v_cvt_pk_bf16_f32 v106, v116, v117
    v_cvt_pk_bf16_f32 v107, v118, v119
    v_cvt_pk_bf16_f32 v108, v120, v121
    v_cvt_pk_bf16_f32 v109, v122, v123
    v_cvt_pk_bf16_f32 v110, v124, v125
    v_cvt_pk_bf16_f32 v111, v126, v127
    s_mov_b32 s47, 2
    s_add_u32 s80, s80, 1
    s_cmp_eq_u32 s80, s81
    s_cbranch_scc1 L_k2_switch
L_k2_t0b2:
    s_waitcnt vmcnt(5)
    ds_read_b128 v[64:67], v22 offset:0
    ds_read_b128 v[68:71], v23 offset:0
    ds_read_u16 v16, v14 offset:512
    ds_read_u16 v17, v14 offset:640
    ds_read_u8 v13, v18 offset:96
    ds_read_u16 v26, v20 offset:320
    ds_read_u16 v28, v20 offset:328
    ds_read_u16 v30, v20 offset:352
    ds_read_u16 v32, v20 offset:360
    ds_read_b32 v34, v19 offset:640
    v_mfma_f32_32x32x16_bf16 v[176:191], v[104:107], v[36:39], v[176:191]
    v_exp_f32 v112, v128
    v_exp_f32 v113, v129
    v_exp_f32 v114, v130
    v_mfma_f32_32x32x16_bf16 v[176:191], v[108:111], v[40:43], v[176:191]
    v_exp_f32 v115, v131
    v_exp_f32 v116, v132
    v_exp_f32 v117, v133
    v_mfma_f32_32x32x16_bf16 v[144:159], v[52:55], v[84:87], 0
    v_exp_f32 v118, v134
    v_exp_f32 v119, v135
    v_exp_f32 v120, v136
    v_mfma_f32_32x32x16_bf16 v[144:159], v[44:47], v[96:99], v[144:159]
    v_exp_f32 v121, v137
    v_exp_f32 v122, v138
    v_exp_f32 v123, v139
    v_exp_f32 v124, v140
    v_exp_f32 v125, v141
    v_exp_f32 v126, v142
    v_exp_f32 v127, v143
    v_pk_add_f32 v[112:113], v[112:113], s[86:87]
    v_pk_add_f32 v[114:115], v[114:115], s[86:87]
    v_pk_add_f32 v[116:117], v[116:117], s[86:87]
    v_pk_add_f32 v[118:119], v[118:119], s[86:87]
    v_pk_add_f32 v[120:121], v[120:121], s[86:87]
    v_pk_add_f32 v[122:123], v[122:123], s[86:87]
    v_pk_add_f32 v[124:125], v[124:125], s[86:87]
    v_pk_add_f32 v[126:127], v[126:127], s[86:87]
    v_mfma_f32_32x32x16_bf16 v[144:159], v[48:51], v[100:103], v[144:159]
    v_rcp_f32 v112, v112
    v_rcp_f32 v113, v113
    s_waitcnt lgkmcnt(0)
    v_lshl_add_u32 v15, v13, 4, v12
    ds_read_b128 v[36:39], v16 offset:1024
    ds_read_b128 v[40:43], v17 offset:1024
    ds_read_b128 v[52:55], v21 offset:0
    ds_read_b128 v[44:47], v15 offset:256
    ds_read_b128 v[48:51], v15
    v_rcp_f32 v114, v114
    v_mfma_f32_32x32x16_bf16 v[144:159], v[56:59], v[72:75], v[144:159]
    v_rcp_f32 v115, v115
    v_rcp_f32 v116, v116
    v_rcp_f32 v117, v117
    v_mfma_f32_32x32x16_bf16 v[144:159], v[60:63], v[76:79], v[144:159]
    v_rcp_f32 v118, v118
    v_rcp_f32 v119, v119
    v_rcp_f32 v120, v120
    v_rcp_f32 v121, v121
    v_rcp_f32 v122, v122
    v_rcp_f32 v123, v123
    v_rcp_f32 v124, v124
    v_rcp_f32 v125, v125
    v_rcp_f32 v126, v126
    v_rcp_f32 v127, v127
    v_pk_mul_f32 v[112:113], v[128:129], v[112:113]
    v_pk_mul_f32 v[114:115], v[130:131], v[114:115]
    v_pk_mul_f32 v[116:117], v[132:133], v[116:117]
    v_pk_mul_f32 v[118:119], v[134:135], v[118:119]
    v_pk_mul_f32 v[120:121], v[136:137], v[120:121]
    v_pk_mul_f32 v[122:123], v[138:139], v[122:123]
    v_pk_mul_f32 v[124:125], v[140:141], v[124:125]
    v_pk_mul_f32 v[126:127], v[142:143], v[126:127]
    v_cvt_pk_bf16_f32 v104, v112, v113
    v_cvt_pk_bf16_f32 v105, v114, v115
    v_cvt_pk_bf16_f32 v106, v116, v117
    v_cvt_pk_bf16_f32 v107, v118, v119
    v_cvt_pk_bf16_f32 v108, v120, v121
    v_cvt_pk_bf16_f32 v109, v122, v123
    v_cvt_pk_bf16_f32 v110, v124, v125
    v_cvt_pk_bf16_f32 v111, v126, v127
    s_waitcnt lgkmcnt(0)
    ds_read_b128 v[56:59], v24 offset:0
    ds_read_b128 v[60:63], v25 offset:0
    v_mfma_f32_32x32x16_bf16 v[160:175], v[104:107], v[36:39], v[160:175]
    v_exp_f32 v112, v144
    v_exp_f32 v113, v145
    v_exp_f32 v114, v146
    v_mfma_f32_32x32x16_bf16 v[160:175], v[108:111], v[40:43], v[160:175]
    v_exp_f32 v115, v147
    v_exp_f32 v116, v148
    v_exp_f32 v117, v149
    v_mfma_f32_32x32x16_bf16 v[128:143], v[52:55], v[80:83], 0
    v_exp_f32 v118, v150
    v_exp_f32 v119, v151
    v_exp_f32 v120, v152
    v_mfma_f32_32x32x16_bf16 v[128:143], v[44:47], v[88:91], v[128:143]
    v_exp_f32 v121, v153
    v_exp_f32 v122, v154
    v_exp_f32 v123, v155
    s_add_u32 m0, s85, 10240
    s_add_u32 s91, s85, 11264
    buffer_load_dwordx4 v[34:35], s[20:23], 0 idxen offen  lds
    s_mov_b32 m0, s91
    s_nop 0
    buffer_load_dwordx4 v[26:27], s[48:51], 0 idxen offen lds
    buffer_load_dwordx4 v[28:29], s[52:55], 0 idxen offen offset:1024 lds
    buffer_load_dwordx4 v[30:31], s[56:59], 0 idxen offen offset:2048 lds
    buffer_load_dwordx4 v[32:33], s[60:63], 0 idxen offen offset:3072 lds
    v_exp_f32 v124, v156
    v_exp_f32 v125, v157
    v_exp_f32 v126, v158
    v_exp_f32 v127, v159
    v_pk_add_f32 v[112:113], v[112:113], s[86:87]
    v_pk_add_f32 v[114:115], v[114:115], s[86:87]
    v_pk_add_f32 v[116:117], v[116:117], s[86:87]
    v_pk_add_f32 v[118:119], v[118:119], s[86:87]
    v_pk_add_f32 v[120:121], v[120:121], s[86:87]
    v_pk_add_f32 v[122:123], v[122:123], s[86:87]
    v_pk_add_f32 v[124:125], v[124:125], s[86:87]
    v_pk_add_f32 v[126:127], v[126:127], s[86:87]
    v_mfma_f32_32x32x16_bf16 v[128:143], v[48:51], v[92:95], v[128:143]
    v_rcp_f32 v112, v112
    v_rcp_f32 v113, v113
    v_rcp_f32 v114, v114
    v_mfma_f32_32x32x16_bf16 v[128:143], v[64:67], v[72:75], v[128:143]
    v_rcp_f32 v115, v115
    v_rcp_f32 v116, v116
    v_rcp_f32 v117, v117
    v_mfma_f32_32x32x16_bf16 v[128:143], v[68:71], v[76:79], v[128:143]
    v_rcp_f32 v118, v118
    v_rcp_f32 v119, v119
    v_rcp_f32 v120, v120
    v_rcp_f32 v121, v121
    v_rcp_f32 v122, v122
    v_rcp_f32 v123, v123
    v_rcp_f32 v124, v124
    v_rcp_f32 v125, v125
    v_rcp_f32 v126, v126
    v_rcp_f32 v127, v127
    v_pk_mul_f32 v[112:113], v[144:145], v[112:113]
    v_pk_mul_f32 v[114:115], v[146:147], v[114:115]
    v_pk_mul_f32 v[116:117], v[148:149], v[116:117]
    v_pk_mul_f32 v[118:119], v[150:151], v[118:119]
    v_pk_mul_f32 v[120:121], v[152:153], v[120:121]
    v_pk_mul_f32 v[122:123], v[154:155], v[122:123]
    v_pk_mul_f32 v[124:125], v[156:157], v[124:125]
    v_pk_mul_f32 v[126:127], v[158:159], v[126:127]
    v_cvt_pk_bf16_f32 v104, v112, v113
    v_cvt_pk_bf16_f32 v105, v114, v115
    v_cvt_pk_bf16_f32 v106, v116, v117
    v_cvt_pk_bf16_f32 v107, v118, v119
    v_cvt_pk_bf16_f32 v108, v120, v121
    v_cvt_pk_bf16_f32 v109, v122, v123
    v_cvt_pk_bf16_f32 v110, v124, v125
    v_cvt_pk_bf16_f32 v111, v126, v127
    v_add_u32 v20, 192, v20
    v_add_u32 v19, 384, v19
    v_add_u32 v18, 96, v18
    v_add_u32 v14, 768, v14
    s_mov_b32 s47, 0
    s_add_u32 s80, s80, 1
    s_cmp_eq_u32 s80, s81
    s_cbranch_scc0 L_k2_t0b0
    s_branch L_k2_switch
L_k2_t1:
    s_setprio 0
    s_cmp_eq_u32 s47, 1
    s_cbranch_scc1 L_k2_t1b1
    s_cmp_eq_u32 s47, 2
    s_cbranch_scc1 L_k2_t1b2
.p2align 6
L_k2_t1b0:
    s_setprio 1
    s_waitcnt vmcnt(5)
    ds_read_b128 v[64:67], v22 offset:5120
    ds_read_b128 v[68:71], v23 offset:5120
    ds_read_u16 v16, v14 offset:0
    ds_read_u16 v17, v14 offset:128
    ds_read_u8 v13, v18 offset:32
    ds_read_u16 v26, v20 offset:192
    ds_read_u16 v28, v20 offset:200
    ds_read_u16 v30, v20 offset:224
    ds_read_u16 v32, v20 offset:232
    ds_read_b32 v34, v19 offset:384
    v_mfma_f32_32x32x16_bf16 v[176:191], v[104:107], v[36:39], v[176:191]
    v_exp_f32 v112, v128
    v_exp_f32 v113, v129
    v_exp_f32 v114, v130
    v_mfma_f32_32x32x16_bf16 v[176:191], v[108:111], v[40:43], v[176:191]
    v_exp_f32 v115, v131
    v_exp_f32 v116, v132
    v_exp_f32 v117, v133
    v_mfma_f32_32x32x16_bf16 v[144:159], v[52:55], v[84:87], 0
    v_exp_f32 v118, v134
    v_exp_f32 v119, v135
    v_exp_f32 v120, v136
    v_mfma_f32_32x32x16_bf16 v[144:159], v[44:47], v[96:99], v[144:159]
    v_exp_f32 v121, v137
    v_exp_f32 v122, v138
    v_exp_f32 v123, v139
    v_exp_f32 v124, v140
    v_exp_f32 v125, v141
    v_exp_f32 v126, v142
    v_exp_f32 v127, v143
    v_pk_add_f32 v[112:113], v[112:113], s[86:87]
    v_pk_add_f32 v[114:115], v[114:115], s[86:87]
    v_pk_add_f32 v[116:117], v[116:117], s[86:87]
    v_pk_add_f32 v[118:119], v[118:119], s[86:87]
    v_pk_add_f32 v[120:121], v[120:121], s[86:87]
    v_pk_add_f32 v[122:123], v[122:123], s[86:87]
    v_pk_add_f32 v[124:125], v[124:125], s[86:87]
    v_pk_add_f32 v[126:127], v[126:127], s[86:87]
    v_mfma_f32_32x32x16_bf16 v[144:159], v[48:51], v[100:103], v[144:159]
    v_rcp_f32 v112, v112
    v_rcp_f32 v113, v113
    s_waitcnt lgkmcnt(0)
    v_lshl_add_u32 v15, v13, 4, v12
    ds_read_b128 v[36:39], v16 offset:1024
    ds_read_b128 v[40:43], v17 offset:1024
    ds_read_b128 v[52:55], v21 offset:5120
    ds_read_b128 v[44:47], v15 offset:256
    ds_read_b128 v[48:51], v15
    v_rcp_f32 v114, v114
    v_mfma_f32_32x32x16_bf16 v[144:159], v[56:59], v[72:75], v[144:159]
    v_rcp_f32 v115, v115
    v_rcp_f32 v116, v116
    v_rcp_f32 v117, v117
    v_mfma_f32_32x32x16_bf16 v[144:159], v[60:63], v[76:79], v[144:159]
    v_rcp_f32 v118, v118
    v_rcp_f32 v119, v119
    v_rcp_f32 v120, v120
    v_rcp_f32 v121, v121
    v_rcp_f32 v122, v122
    v_rcp_f32 v123, v123
    v_rcp_f32 v124, v124
    v_rcp_f32 v125, v125
    v_rcp_f32 v126, v126
    v_rcp_f32 v127, v127
    v_pk_mul_f32 v[112:113], v[128:129], v[112:113]
    v_pk_mul_f32 v[114:115], v[130:131], v[114:115]
    v_pk_mul_f32 v[116:117], v[132:133], v[116:117]
    v_pk_mul_f32 v[118:119], v[134:135], v[118:119]
    v_pk_mul_f32 v[120:121], v[136:137], v[120:121]
    v_pk_mul_f32 v[122:123], v[138:139], v[122:123]
    v_pk_mul_f32 v[124:125], v[140:141], v[124:125]
    v_pk_mul_f32 v[126:127], v[142:143], v[126:127]
    v_cvt_pk_bf16_f32 v104, v112, v113
    v_cvt_pk_bf16_f32 v105, v114, v115
    v_cvt_pk_bf16_f32 v106, v116, v117
    v_cvt_pk_bf16_f32 v107, v118, v119
    v_cvt_pk_bf16_f32 v108, v120, v121
    v_cvt_pk_bf16_f32 v109, v122, v123
    v_cvt_pk_bf16_f32 v110, v124, v125
    v_cvt_pk_bf16_f32 v111, v126, v127
    s_waitcnt lgkmcnt(0)
    ds_read_b128 v[56:59], v24 offset:5120
    ds_read_b128 v[60:63], v25 offset:5120
    v_mfma_f32_32x32x16_bf16 v[160:175], v[104:107], v[36:39], v[160:175]
    v_exp_f32 v112, v144
    v_exp_f32 v113, v145
    v_exp_f32 v114, v146
    v_mfma_f32_32x32x16_bf16 v[160:175], v[108:111], v[40:43], v[160:175]
    v_exp_f32 v115, v147
    v_exp_f32 v116, v148
    v_exp_f32 v117, v149
    v_mfma_f32_32x32x16_bf16 v[128:143], v[52:55], v[80:83], 0
    v_exp_f32 v118, v150
    v_exp_f32 v119, v151
    v_exp_f32 v120, v152
    v_mfma_f32_32x32x16_bf16 v[128:143], v[44:47], v[88:91], v[128:143]
    v_exp_f32 v121, v153
    v_exp_f32 v122, v154
    v_exp_f32 v123, v155
    s_add_u32 m0, s85, 0
    s_add_u32 s91, s85, 1024
    buffer_load_dwordx4 v[34:35], s[20:23], 0 idxen offen  lds
    s_mov_b32 m0, s91
    s_nop 0
    buffer_load_dwordx4 v[26:27], s[48:51], 0 idxen offen lds
    buffer_load_dwordx4 v[28:29], s[52:55], 0 idxen offen offset:1024 lds
    buffer_load_dwordx4 v[30:31], s[56:59], 0 idxen offen offset:2048 lds
    buffer_load_dwordx4 v[32:33], s[60:63], 0 idxen offen offset:3072 lds
    v_exp_f32 v124, v156
    v_exp_f32 v125, v157
    v_exp_f32 v126, v158
    v_exp_f32 v127, v159
    v_pk_add_f32 v[112:113], v[112:113], s[86:87]
    v_pk_add_f32 v[114:115], v[114:115], s[86:87]
    v_pk_add_f32 v[116:117], v[116:117], s[86:87]
    v_pk_add_f32 v[118:119], v[118:119], s[86:87]
    v_pk_add_f32 v[120:121], v[120:121], s[86:87]
    v_pk_add_f32 v[122:123], v[122:123], s[86:87]
    v_pk_add_f32 v[124:125], v[124:125], s[86:87]
    v_pk_add_f32 v[126:127], v[126:127], s[86:87]
    v_mfma_f32_32x32x16_bf16 v[128:143], v[48:51], v[92:95], v[128:143]
    v_rcp_f32 v112, v112
    v_rcp_f32 v113, v113
    v_rcp_f32 v114, v114
    v_mfma_f32_32x32x16_bf16 v[128:143], v[64:67], v[72:75], v[128:143]
    v_rcp_f32 v115, v115
    v_rcp_f32 v116, v116
    v_rcp_f32 v117, v117
    v_mfma_f32_32x32x16_bf16 v[128:143], v[68:71], v[76:79], v[128:143]
    v_rcp_f32 v118, v118
    v_rcp_f32 v119, v119
    v_rcp_f32 v120, v120
    v_rcp_f32 v121, v121
    v_rcp_f32 v122, v122
    v_rcp_f32 v123, v123
    v_rcp_f32 v124, v124
    v_rcp_f32 v125, v125
    v_rcp_f32 v126, v126
    v_rcp_f32 v127, v127
    v_pk_mul_f32 v[112:113], v[144:145], v[112:113]
    v_pk_mul_f32 v[114:115], v[146:147], v[114:115]
    v_pk_mul_f32 v[116:117], v[148:149], v[116:117]
    v_pk_mul_f32 v[118:119], v[150:151], v[118:119]
    v_pk_mul_f32 v[120:121], v[152:153], v[120:121]
    v_pk_mul_f32 v[122:123], v[154:155], v[122:123]
    v_pk_mul_f32 v[124:125], v[156:157], v[124:125]
    v_pk_mul_f32 v[126:127], v[158:159], v[126:127]
    v_cvt_pk_bf16_f32 v104, v112, v113
    v_cvt_pk_bf16_f32 v105, v114, v115
    v_cvt_pk_bf16_f32 v106, v116, v117
    v_cvt_pk_bf16_f32 v107, v118, v119
    v_cvt_pk_bf16_f32 v108, v120, v121
    v_cvt_pk_bf16_f32 v109, v122, v123
    v_cvt_pk_bf16_f32 v110, v124, v125
    v_cvt_pk_bf16_f32 v111, v126, v127
    s_mov_b32 s47, 1
    s_add_u32 s80, s80, 1
    s_cmp_eq_u32 s80, s81
    s_cbranch_scc1 L_k2_switch
L_k2_t1b1:
    s_setprio 1
    s_waitcnt vmcnt(5)
    ds_read_b128 v[64:67], v22 offset:10240
    ds_read_b128 v[68:71], v23 offset:10240
    ds_read_u16 v16, v14 offset:256
    ds_read_u16 v17, v14 offset:384
    ds_read_u8 v13, v18 offset:64
    ds_read_u16 v26, v20 offset:256
    ds_read_u16 v28, v20 offset:264
    ds_read_u16 v30, v20 offset:288
    ds_read_u16 v32, v20 offset:296
    ds_read_b32 v34, v19 offset:512
    v_mfma_f32_32x32x16_bf16 v[176:191], v[104:107], v[36:39], v[176:191]
    v_exp_f32 v112, v128
    v_exp_f32 v113, v129
    v_exp_f32 v114, v130
    v_mfma_f32_32x32x16_bf16 v[176:191], v[108:111], v[40:43], v[176:191]
    v_exp_f32 v115, v131
    v_exp_f32 v116, v132
    v_exp_f32 v117, v133
    v_mfma_f32_32x32x16_bf16 v[144:159], v[52:55], v[84:87], 0
    v_exp_f32 v118, v134
    v_exp_f32 v119, v135
    v_exp_f32 v120, v136
    v_mfma_f32_32x32x16_bf16 v[144:159], v[44:47], v[96:99], v[144:159]
    v_exp_f32 v121, v137
    v_exp_f32 v122, v138
    v_exp_f32 v123, v139
    v_exp_f32 v124, v140
    v_exp_f32 v125, v141
    v_exp_f32 v126, v142
    v_exp_f32 v127, v143
    v_pk_add_f32 v[112:113], v[112:113], s[86:87]
    v_pk_add_f32 v[114:115], v[114:115], s[86:87]
    v_pk_add_f32 v[116:117], v[116:117], s[86:87]
    v_pk_add_f32 v[118:119], v[118:119], s[86:87]
    v_pk_add_f32 v[120:121], v[120:121], s[86:87]
    v_pk_add_f32 v[122:123], v[122:123], s[86:87]
    v_pk_add_f32 v[124:125], v[124:125], s[86:87]
    v_pk_add_f32 v[126:127], v[126:127], s[86:87]
    v_mfma_f32_32x32x16_bf16 v[144:159], v[48:51], v[100:103], v[144:159]
    v_rcp_f32 v112, v112
    v_rcp_f32 v113, v113
    s_waitcnt lgkmcnt(0)
    v_lshl_add_u32 v15, v13, 4, v12
    ds_read_b128 v[36:39], v16 offset:1024
    ds_read_b128 v[40:43], v17 offset:1024
    ds_read_b128 v[52:55], v21 offset:10240
    ds_read_b128 v[44:47], v15 offset:256
    ds_read_b128 v[48:51], v15
    v_rcp_f32 v114, v114
    v_mfma_f32_32x32x16_bf16 v[144:159], v[56:59], v[72:75], v[144:159]
    v_rcp_f32 v115, v115
    v_rcp_f32 v116, v116
    v_rcp_f32 v117, v117
    v_mfma_f32_32x32x16_bf16 v[144:159], v[60:63], v[76:79], v[144:159]
    v_rcp_f32 v118, v118
    v_rcp_f32 v119, v119
    v_rcp_f32 v120, v120
    v_rcp_f32 v121, v121
    v_rcp_f32 v122, v122
    v_rcp_f32 v123, v123
    v_rcp_f32 v124, v124
    v_rcp_f32 v125, v125
    v_rcp_f32 v126, v126
    v_rcp_f32 v127, v127
    v_pk_mul_f32 v[112:113], v[128:129], v[112:113]
    v_pk_mul_f32 v[114:115], v[130:131], v[114:115]
    v_pk_mul_f32 v[116:117], v[132:133], v[116:117]
    v_pk_mul_f32 v[118:119], v[134:135], v[118:119]
    v_pk_mul_f32 v[120:121], v[136:137], v[120:121]
    v_pk_mul_f32 v[122:123], v[138:139], v[122:123]
    v_pk_mul_f32 v[124:125], v[140:141], v[124:125]
    v_pk_mul_f32 v[126:127], v[142:143], v[126:127]
    v_cvt_pk_bf16_f32 v104, v112, v113
    v_cvt_pk_bf16_f32 v105, v114, v115
    v_cvt_pk_bf16_f32 v106, v116, v117
    v_cvt_pk_bf16_f32 v107, v118, v119
    v_cvt_pk_bf16_f32 v108, v120, v121
    v_cvt_pk_bf16_f32 v109, v122, v123
    v_cvt_pk_bf16_f32 v110, v124, v125
    v_cvt_pk_bf16_f32 v111, v126, v127
    s_waitcnt lgkmcnt(0)
    ds_read_b128 v[56:59], v24 offset:10240
    ds_read_b128 v[60:63], v25 offset:10240
    v_mfma_f32_32x32x16_bf16 v[160:175], v[104:107], v[36:39], v[160:175]
    v_exp_f32 v112, v144
    v_exp_f32 v113, v145
    v_exp_f32 v114, v146
    v_mfma_f32_32x32x16_bf16 v[160:175], v[108:111], v[40:43], v[160:175]
    v_exp_f32 v115, v147
    v_exp_f32 v116, v148
    v_exp_f32 v117, v149
    v_mfma_f32_32x32x16_bf16 v[128:143], v[52:55], v[80:83], 0
    v_exp_f32 v118, v150
    v_exp_f32 v119, v151
    v_exp_f32 v120, v152
    v_mfma_f32_32x32x16_bf16 v[128:143], v[44:47], v[88:91], v[128:143]
    v_exp_f32 v121, v153
    v_exp_f32 v122, v154
    v_exp_f32 v123, v155
    s_add_u32 m0, s85, 5120
    s_add_u32 s91, s85, 6144
    buffer_load_dwordx4 v[34:35], s[20:23], 0 idxen offen  lds
    s_mov_b32 m0, s91
    s_nop 0
    buffer_load_dwordx4 v[26:27], s[48:51], 0 idxen offen lds
    buffer_load_dwordx4 v[28:29], s[52:55], 0 idxen offen offset:1024 lds
    buffer_load_dwordx4 v[30:31], s[56:59], 0 idxen offen offset:2048 lds
    buffer_load_dwordx4 v[32:33], s[60:63], 0 idxen offen offset:3072 lds
    v_exp_f32 v124, v156
    v_exp_f32 v125, v157
    v_exp_f32 v126, v158
    v_exp_f32 v127, v159
    v_pk_add_f32 v[112:113], v[112:113], s[86:87]
    v_pk_add_f32 v[114:115], v[114:115], s[86:87]
    v_pk_add_f32 v[116:117], v[116:117], s[86:87]
    v_pk_add_f32 v[118:119], v[118:119], s[86:87]
    v_pk_add_f32 v[120:121], v[120:121], s[86:87]
    v_pk_add_f32 v[122:123], v[122:123], s[86:87]
    v_pk_add_f32 v[124:125], v[124:125], s[86:87]
    v_pk_add_f32 v[126:127], v[126:127], s[86:87]
    v_mfma_f32_32x32x16_bf16 v[128:143], v[48:51], v[92:95], v[128:143]
    v_rcp_f32 v112, v112
    v_rcp_f32 v113, v113
    v_rcp_f32 v114, v114
    v_mfma_f32_32x32x16_bf16 v[128:143], v[64:67], v[72:75], v[128:143]
    v_rcp_f32 v115, v115
    v_rcp_f32 v116, v116
    v_rcp_f32 v117, v117
    v_mfma_f32_32x32x16_bf16 v[128:143], v[68:71], v[76:79], v[128:143]
    v_rcp_f32 v118, v118
    v_rcp_f32 v119, v119
    v_rcp_f32 v120, v120
    v_rcp_f32 v121, v121
    v_rcp_f32 v122, v122
    v_rcp_f32 v123, v123
    v_rcp_f32 v124, v124
    v_rcp_f32 v125, v125
    v_rcp_f32 v126, v126
    v_rcp_f32 v127, v127
    v_pk_mul_f32 v[112:113], v[144:145], v[112:113]
    v_pk_mul_f32 v[114:115], v[146:147], v[114:115]
    v_pk_mul_f32 v[116:117], v[148:149], v[116:117]
    v_pk_mul_f32 v[118:119], v[150:151], v[118:119]
    v_pk_mul_f32 v[120:121], v[152:153], v[120:121]
    v_pk_mul_f32 v[122:123], v[154:155], v[122:123]
    v_pk_mul_f32 v[124:125], v[156:157], v[124:125]
    v_pk_mul_f32 v[126:127], v[158:159], v[126:127]
    v_cvt_pk_bf16_f32 v104, v112, v113
    v_cvt_pk_bf16_f32 v105, v114, v115
    v_cvt_pk_bf16_f32 v106, v116, v117
    v_cvt_pk_bf16_f32 v107, v118, v119
    v_cvt_pk_bf16_f32 v108, v120, v121
    v_cvt_pk_bf16_f32 v109, v122, v123
    v_cvt_pk_bf16_f32 v110, v124, v125
    v_cvt_pk_bf16_f32 v111, v126, v127
    s_mov_b32 s47, 2
    s_add_u32 s80, s80, 1
    s_cmp_eq_u32 s80, s81
    s_cbranch_scc1 L_k2_switch
L_k2_t1b2:
    s_setprio 0
    s_waitcnt vmcnt(5)
    ds_read_b128 v[64:67], v22 offset:0
    ds_read_b128 v[68:71], v23 offset:0
    ds_read_u16 v16, v14 offset:512
    ds_read_u16 v17, v14 offset:640
    ds_read_u8 v13, v18 offset:96
    ds_read_u16 v26, v20 offset:320
    ds_read_u16 v28, v20 offset:328
    ds_read_u16 v30, v20 offset:352
    ds_read_u16 v32, v20 offset:360
    ds_read_b32 v34, v19 offset:640
    v_mfma_f32_32x32x16_bf16 v[176:191], v[104:107], v[36:39], v[176:191]
    v_exp_f32 v112, v128
    v_exp_f32 v113, v129
    v_exp_f32 v114, v130
    v_mfma_f32_32x32x16_bf16 v[176:191], v[108:111], v[40:43], v[176:191]
    v_exp_f32 v115, v131
    v_exp_f32 v116, v132
    v_exp_f32 v117, v133
    v_mfma_f32_32x32x16_bf16 v[144:159], v[52:55], v[84:87], 0
    v_exp_f32 v118, v134
    v_exp_f32 v119, v135
    v_exp_f32 v120, v136
    v_mfma_f32_32x32x16_bf16 v[144:159], v[44:47], v[96:99], v[144:159]
    v_exp_f32 v121, v137
    v_exp_f32 v122, v138
    v_exp_f32 v123, v139
    v_exp_f32 v124, v140
    v_exp_f32 v125, v141
    v_exp_f32 v126, v142
    v_exp_f32 v127, v143
    v_pk_add_f32 v[112:113], v[112:113], s[86:87]
    v_pk_add_f32 v[114:115], v[114:115], s[86:87]
    v_pk_add_f32 v[116:117], v[116:117], s[86:87]
    v_pk_add_f32 v[118:119], v[118:119], s[86:87]
    v_pk_add_f32 v[120:121], v[120:121], s[86:87]
    v_pk_add_f32 v[122:123], v[122:123], s[86:87]
    v_pk_add_f32 v[124:125], v[124:125], s[86:87]
    v_pk_add_f32 v[126:127], v[126:127], s[86:87]
    v_mfma_f32_32x32x16_bf16 v[144:159], v[48:51], v[100:103], v[144:159]
    v_rcp_f32 v112, v112
    v_rcp_f32 v113, v113
    s_waitcnt lgkmcnt(0)
    v_lshl_add_u32 v15, v13, 4, v12
    ds_read_b128 v[36:39], v16 offset:1024
    ds_read_b128 v[40:43], v17 offset:1024
    ds_read_b128 v[52:55], v21 offset:0
    ds_read_b128 v[44:47], v15 offset:256
    ds_read_b128 v[48:51], v15
    v_rcp_f32 v114, v114
    v_mfma_f32_32x32x16_bf16 v[144:159], v[56:59], v[72:75], v[144:159]
    v_rcp_f32 v115, v115
    v_rcp_f32 v116, v116
    v_rcp_f32 v117, v117
    v_mfma_f32_32x32x16_bf16 v[144:159], v[60:63], v[76:79], v[144:159]
    v_rcp_f32 v118, v118
    v_rcp_f32 v119, v119
    v_rcp_f32 v120, v120
    v_rcp_f32 v121, v121
    v_rcp_f32 v122, v122
    v_rcp_f32 v123, v123
    v_rcp_f32 v124, v124
    v_rcp_f32 v125, v125
    v_rcp_f32 v126, v126
    v_rcp_f32 v127, v127
    v_pk_mul_f32 v[112:113], v[128:129], v[112:113]
    v_pk_mul_f32 v[114:115], v[130:131], v[114:115]
    v_pk_mul_f32 v[116:117], v[132:133], v[116:117]
    v_pk_mul_f32 v[118:119], v[134:135], v[118:119]
    v_pk_mul_f32 v[120:121], v[136:137], v[120:121]
    v_pk_mul_f32 v[122:123], v[138:139], v[122:123]
    v_pk_mul_f32 v[124:125], v[140:141], v[124:125]
    v_pk_mul_f32 v[126:127], v[142:143], v[126:127]
    v_cvt_pk_bf16_f32 v104, v112, v113
    v_cvt_pk_bf16_f32 v105, v114, v115
    v_cvt_pk_bf16_f32 v106, v116, v117
    v_cvt_pk_bf16_f32 v107, v118, v119
    v_cvt_pk_bf16_f32 v108, v120, v121
    v_cvt_pk_bf16_f32 v109, v122, v123
    v_cvt_pk_bf16_f32 v110, v124, v125
    v_cvt_pk_bf16_f32 v111, v126, v127
    s_waitcnt lgkmcnt(0)
    ds_read_b128 v[56:59], v24 offset:0
    ds_read_b128 v[60:63], v25 offset:0
    v_mfma_f32_32x32x16_bf16 v[160:175], v[104:107], v[36:39], v[160:175]
    v_exp_f32 v112, v144
    v_exp_f32 v113, v145
    v_exp_f32 v114, v146
    v_mfma_f32_32x32x16_bf16 v[160:175], v[108:111], v[40:43], v[160:175]
    v_exp_f32 v115, v147
    v_exp_f32 v116, v148
    v_exp_f32 v117, v149
    v_mfma_f32_32x32x16_bf16 v[128:143], v[52:55], v[80:83], 0
    v_exp_f32 v118, v150
    v_exp_f32 v119, v151
    v_exp_f32 v120, v152
    v_mfma_f32_32x32x16_bf16 v[128:143], v[44:47], v[88:91], v[128:143]
    v_exp_f32 v121, v153
    v_exp_f32 v122, v154
    v_exp_f32 v123, v155
    s_add_u32 m0, s85, 10240
    s_add_u32 s91, s85, 11264
    buffer_load_dwordx4 v[34:35], s[20:23], 0 idxen offen  lds
    s_mov_b32 m0, s91
    s_nop 0
    buffer_load_dwordx4 v[26:27], s[48:51], 0 idxen offen lds
    buffer_load_dwordx4 v[28:29], s[52:55], 0 idxen offen offset:1024 lds
    buffer_load_dwordx4 v[30:31], s[56:59], 0 idxen offen offset:2048 lds
    buffer_load_dwordx4 v[32:33], s[60:63], 0 idxen offen offset:3072 lds
    v_exp_f32 v124, v156
    v_exp_f32 v125, v157
    v_exp_f32 v126, v158
    v_exp_f32 v127, v159
    v_pk_add_f32 v[112:113], v[112:113], s[86:87]
    v_pk_add_f32 v[114:115], v[114:115], s[86:87]
    v_pk_add_f32 v[116:117], v[116:117], s[86:87]
    v_pk_add_f32 v[118:119], v[118:119], s[86:87]
    v_pk_add_f32 v[120:121], v[120:121], s[86:87]
    v_pk_add_f32 v[122:123], v[122:123], s[86:87]
    v_pk_add_f32 v[124:125], v[124:125], s[86:87]
    v_pk_add_f32 v[126:127], v[126:127], s[86:87]
    v_mfma_f32_32x32x16_bf16 v[128:143], v[48:51], v[92:95], v[128:143]
    v_rcp_f32 v112, v112
    v_rcp_f32 v113, v113
    v_rcp_f32 v114, v114
    v_mfma_f32_32x32x16_bf16 v[128:143], v[64:67], v[72:75], v[128:143]
    v_rcp_f32 v115, v115
    v_rcp_f32 v116, v116
    v_rcp_f32 v117, v117
    v_mfma_f32_32x32x16_bf16 v[128:143], v[68:71], v[76:79], v[128:143]
    v_rcp_f32 v118, v118
    v_rcp_f32 v119, v119
    v_rcp_f32 v120, v120
    v_rcp_f32 v121, v121
    v_rcp_f32 v122, v122
    v_rcp_f32 v123, v123
    v_rcp_f32 v124, v124
    v_rcp_f32 v125, v125
    v_rcp_f32 v126, v126
    v_rcp_f32 v127, v127
    v_pk_mul_f32 v[112:113], v[144:145], v[112:113]
    v_pk_mul_f32 v[114:115], v[146:147], v[114:115]
    v_pk_mul_f32 v[116:117], v[148:149], v[116:117]
    v_pk_mul_f32 v[118:119], v[150:151], v[118:119]
    v_pk_mul_f32 v[120:121], v[152:153], v[120:121]
    v_pk_mul_f32 v[122:123], v[154:155], v[122:123]
    v_pk_mul_f32 v[124:125], v[156:157], v[124:125]
    v_pk_mul_f32 v[126:127], v[158:159], v[126:127]
    v_cvt_pk_bf16_f32 v104, v112, v113
    v_cvt_pk_bf16_f32 v105, v114, v115
    v_cvt_pk_bf16_f32 v106, v116, v117
    v_cvt_pk_bf16_f32 v107, v118, v119
    v_cvt_pk_bf16_f32 v108, v120, v121
    v_cvt_pk_bf16_f32 v109, v122, v123
    v_cvt_pk_bf16_f32 v110, v124, v125
    v_cvt_pk_bf16_f32 v111, v126, v127
    v_add_u32 v20, 192, v20
    v_add_u32 v19, 384, v19
    v_add_u32 v18, 96, v18
    v_add_u32 v14, 768, v14
    s_mov_b32 s47, 0
    s_add_u32 s80, s80, 1
    s_cmp_eq_u32 s80, s81
    s_cbranch_scc0 L_k2_t1b0
L_k2_switch:
    s_setprio 2
    v_mfma_f32_32x32x16_bf16 v[176:191], v[104:107], v[36:39], v[176:191]
    v_mfma_f32_32x32x16_bf16 v[176:191], v[108:111], v[40:43], v[176:191]
    s_cmp_eq_u32 s82, 0
    s_cbranch_scc0 L_k2_final
    s_mov_b32 s82, 1
    s_mov_b32 s81, s84
    v_mov_b64 v[88:89], v[224:225]
    v_mov_b64 v[90:91], v[226:227]
    v_mov_b64 v[92:93], v[228:229]
    v_mov_b64 v[94:95], v[230:231]
    v_mov_b64 v[96:97], v[232:233]
    v_mov_b64 v[98:99], v[234:235]
    v_mov_b64 v[100:101], v[236:237]
    v_mov_b64 v[102:103], v[238:239]
    s_nop 1
    s_lshl_b32 s91, s46, 12
    s_add_u32 s91, s91, 8192
    buffer_load_dwordx4 v[224:227], v4, s[32:35], s91 offen offset:0
    buffer_load_dwordx4 v[228:231], v4, s[32:35], s91 offen offset:1024
    buffer_load_dwordx4 v[232:235], v4, s[32:35], s91 offen offset:2048
    buffer_load_dwordx4 v[236:239], v4, s[32:35], s91 offen offset:3072
    s_add_u32 s91, s91, 16384
    buffer_load_dwordx4 v[240:243], v4, s[32:35], s91 offen offset:0
    buffer_load_dwordx4 v[244:247], v4, s[32:35], s91 offen offset:1024
    buffer_load_dwordx4 v[248:251], v4, s[32:35], s91 offen offset:2048
    buffer_load_dwordx4 v[252:255], v4, s[32:35], s91 offen offset:3072
    v_mov_b64 v[104:105], 0
    v_mov_b64 v[106:107], 0
    v_mov_b64 v[108:109], 0
    v_mov_b64 v[110:111], 0
    s_nop 7
    v_mov_b64 v[192:193], v[160:161]
    v_mov_b64 v[194:195], v[162:163]
    v_mov_b64 v[196:197], v[164:165]
    v_mov_b64 v[198:199], v[166:167]
    v_mov_b64 v[200:201], v[168:169]
    v_mov_b64 v[202:203], v[170:171]
    v_mov_b64 v[204:205], v[172:173]
    v_mov_b64 v[206:207], v[174:175]
    v_mov_b64 v[208:209], v[176:177]
    v_mov_b64 v[210:211], v[178:179]
    v_mov_b64 v[212:213], v[180:181]
    v_mov_b64 v[214:215], v[182:183]
    v_mov_b64 v[216:217], v[184:185]
    v_mov_b64 v[218:219], v[186:187]
    v_mov_b64 v[220:221], v[188:189]
    v_mov_b64 v[222:223], v[190:191]
    s_nop 7
    v_mov_b64 v[160:161], 0
    v_mov_b64 v[162:163], 0
    v_mov_b64 v[164:165], 0
    v_mov_b64 v[166:167], 0
    v_mov_b64 v[168:169], 0
    v_mov_b64 v[170:171], 0
    v_mov_b64 v[172:173], 0
    v_mov_b64 v[174:175], 0
    v_mov_b64 v[176:177], 0
    v_mov_b64 v[178:179], 0
    v_mov_b64 v[180:181], 0
    v_mov_b64 v[182:183], 0
    v_mov_b64 v[184:185], 0
    v_mov_b64 v[186:187], 0
    v_mov_b64 v[188:189], 0
    v_mov_b64 v[190:191], 0
    s_branch L_k2_begin
L_k2_final:
    s_lshl_b32 s91, s46, 12
    s_add_u32 s91, s91, 40960
    buffer_load_dwordx4 v[128:131], v4, s[32:35], s91 offen offset:0
    buffer_load_dwordx4 v[132:135], v4, s[32:35], s91 offen offset:1024
    buffer_load_dwordx4 v[136:139], v4, s[32:35], s91 offen offset:2048
    buffer_load_dwordx4 v[140:143], v4, s[32:35], s91 offen offset:3072
    s_add_u32 s91, s91, 16384
    buffer_load_dwordx4 v[144:147], v4, s[32:35], s91 offen offset:0
    buffer_load_dwordx4 v[148:151], v4, s[32:35], s91 offen offset:1024
    buffer_load_dwordx4 v[152:155], v4, s[32:35], s91 offen offset:2048
    buffer_load_dwordx4 v[156:159], v4, s[32:35], s91 offen offset:3072
    s_waitcnt vmcnt(8)
    v_add_u32 v5, s85, v4
    v_cvt_pk_bf16_f32 v112, v192, v193
    v_cvt_pk_bf16_f32 v113, v194, v195
    v_cvt_pk_bf16_f32 v114, v196, v197
    v_cvt_pk_bf16_f32 v115, v198, v199
    v_cvt_pk_bf16_f32 v116, v200, v201
    v_cvt_pk_bf16_f32 v117, v202, v203
    v_cvt_pk_bf16_f32 v118, v204, v205
    v_cvt_pk_bf16_f32 v119, v206, v207
    v_cvt_pk_bf16_f32 v120, v208, v209
    v_cvt_pk_bf16_f32 v121, v210, v211
    v_cvt_pk_bf16_f32 v122, v212, v213
    v_cvt_pk_bf16_f32 v123, v214, v215
    v_cvt_pk_bf16_f32 v124, v216, v217
    v_cvt_pk_bf16_f32 v125, v218, v219
    v_cvt_pk_bf16_f32 v126, v220, v221
    v_cvt_pk_bf16_f32 v127, v222, v223
    ds_write_b128 v5, v[112:115] offset:0
    ds_write_b128 v5, v[116:119] offset:1024
    ds_write_b128 v5, v[120:123] offset:2048
    ds_write_b128 v5, v[124:127] offset:3072
    s_waitcnt lgkmcnt(0)
    v_cvt_pk_bf16_f32 v112, v160, v161
    v_cvt_pk_bf16_f32 v113, v162, v163
    v_cvt_pk_bf16_f32 v114, v164, v165
    v_cvt_pk_bf16_f32 v115, v166, v167
    v_cvt_pk_bf16_f32 v116, v168, v169
    v_cvt_pk_bf16_f32 v117, v170, v171
    v_cvt_pk_bf16_f32 v118, v172, v173
    v_cvt_pk_bf16_f32 v119, v174, v175
    v_cvt_pk_bf16_f32 v120, v176, v177
    v_cvt_pk_bf16_f32 v121, v178, v179
    v_cvt_pk_bf16_f32 v122, v180, v181
    v_cvt_pk_bf16_f32 v123, v182, v183
    v_cvt_pk_bf16_f32 v124, v184, v185
    v_cvt_pk_bf16_f32 v125, v186, v187
    v_cvt_pk_bf16_f32 v126, v188, v189
    v_cvt_pk_bf16_f32 v127, v190, v191
    ds_write_b128 v5, v[112:115] offset:4096
    ds_write_b128 v5, v[116:119] offset:5120
    ds_write_b128 v5, v[120:123] offset:6144
    ds_write_b128 v5, v[124:127] offset:7168
    s_waitcnt lgkmcnt(0)
    s_lshl_b32 s93, s45, 2
    s_add_u32 s93, s93, 5392
    v_mov_b32 v113, s93
    v_mov_b32 v115, 1
    s_mov_b64 exec, 1
    ds_add_u32 v113, v115
    s_mov_b64 exec, -1
    s_mul_i32 s92, s45, 61440
    s_add_u32 s92, s92, 40192
    v_add_u32 v5, s92, v4
    s_lshl_b32 s92, s46, 7
    s_add_u32 s92, s92, 5952
    v_lshlrev_b32 v8, 4, v3
    v_add_u32 v8, s92, v8
L_k2_spin:
    ds_read_b32 v114, v113
    s_waitcnt lgkmcnt(0)
    v_readfirstlane_b32 s93, v114
    s_cmp_ge_u32 s93, 4
    s_cbranch_scc1 L_k2_spin_ok
    s_sleep 1
    s_branch L_k2_spin
L_k2_spin_ok:
    ds_read_b128 v[192:195], v5 offset:0
    ds_read_b128 v[196:199], v5 offset:1024
    ds_read_b128 v[200:203], v5 offset:2048
    ds_read_b128 v[204:207], v5 offset:3072
    ds_read_b128 v[208:211], v5 offset:15360
    ds_read_b128 v[212:215], v5 offset:16384
    ds_read_b128 v[216:219], v5 offset:17408
    ds_read_b128 v[220:223], v5 offset:18432
    s_waitcnt lgkmcnt(4)
    ds_read_b128 v[160:163], v5 offset:30720
    ds_read_b128 v[164:167], v5 offset:31744
    ds_read_b128 v[168:171], v5 offset:32768
    ds_read_b128 v[172:175], v5 offset:33792
    ds_read_b128 v[176:179], v5 offset:46080
    ds_read_b128 v[180:183], v5 offset:47104
    ds_read_b128 v[184:187], v5 offset:48128
    ds_read_b128 v[188:191], v5 offset:49152
    s_lshl_b32 s92, s2, 2
    s_lshl_b32 s93, s45, 1
    s_add_u32 s92, s92, s93
    s_add_u32 s92, s92, 0
    s_mul_i32 s89, s92, 3125
    s_lshr_b32 s89, s89, 7
    s_add_u32 s95, s92, 1
    s_mul_i32 s90, s95, 3125
    s_lshr_b32 s90, s90, 7
    s_sub_u32 s90, s90, s89
    s_lshl_b32 s92, s45, 1
    s_add_u32 s92, s92, 0
    s_lshl_b32 s92, s92, 7
    s_add_u32 s92, s92, 5440
    v_lshlrev_b32 v6, 2, v2
    v_add_u32 v6, s92, v6
    ds_read_b32 v7, v6
    s_waitcnt vmcnt(0)
    s_waitcnt lgkmcnt(0)
    v_mfma_f32_32x32x16_bf16 v[112:127], v[224:227], v[192:195], 0
    v_mfma_f32_32x32x16_bf16 v[112:127], v[228:231], v[196:199], v[112:127]
    v_mfma_f32_32x32x16_bf16 v[112:127], v[232:235], v[200:203], v[112:127]
    v_mfma_f32_32x32x16_bf16 v[112:127], v[236:239], v[204:207], v[112:127]
    v_mfma_f32_32x32x16_bf16 v[112:127], v[240:243], v[208:211], v[112:127]
    v_mfma_f32_32x32x16_bf16 v[112:127], v[244:247], v[212:215], v[112:127]
    v_mfma_f32_32x32x16_bf16 v[112:127], v[248:251], v[216:219], v[112:127]
    v_mfma_f32_32x32x16_bf16 v[112:127], v[252:255], v[220:223], v[112:127]
    v_mfma_f32_32x32x16_bf16 v[112:127], v[128:131], v[160:163], v[112:127]
    v_mfma_f32_32x32x16_bf16 v[112:127], v[132:135], v[164:167], v[112:127]
    v_mfma_f32_32x32x16_bf16 v[112:127], v[136:139], v[168:171], v[112:127]
    v_mfma_f32_32x32x16_bf16 v[112:127], v[140:143], v[172:175], v[112:127]
    v_mfma_f32_32x32x16_bf16 v[112:127], v[144:147], v[176:179], v[112:127]
    v_mfma_f32_32x32x16_bf16 v[112:127], v[148:151], v[180:183], v[112:127]
    v_mfma_f32_32x32x16_bf16 v[112:127], v[152:155], v[184:187], v[112:127]
    v_mfma_f32_32x32x16_bf16 v[112:127], v[156:159], v[188:191], v[112:127]
    v_cvt_f32_u32 v9, v7
    s_nop 15
    ds_read_b128 v[192:195], v8 offset:0
    ds_read_b128 v[196:199], v8 offset:32
    ds_read_b128 v[200:203], v8 offset:64
    ds_read_b128 v[204:207], v8 offset:96
    s_add_u32 s92, s85, 8192
    v_lshrrev_b32 v10, 1, v2
    v_and_b32 v10, 3, v10
    v_lshlrev_b32 v10, 4, v10
    v_lshl_add_u32 v10, v2, 6, v10
    v_lshl_add_u32 v10, v3, 3, v10
    v_add_u32 v10, s92, v10
    v_lshrrev_b32 v12, 2, v1
    v_lshrrev_b32 v13, 1, v12
    v_and_b32 v13, 3, v13
    v_and_b32 v14, 3, v1
    v_xor_b32 v13, v13, v14
    v_lshlrev_b32 v13, 4, v13
    v_lshl_add_u32 v13, v12, 6, v13
    v_add_u32 v13, s92, v13
    s_lshl_b32 s92, s46, 6
    v_lshl_add_u32 v14, v14, 4, s92
    v_mov_b32 v15, 0x7ffffff0
    v_add_u32 v6, s89, v12
    v_cmp_gt_u32 vcc, s90, v12
    v_lshl_add_u32 v6, v6, 8, v14
    v_add_u32 v7, 16, v12
    v_cndmask_b32 v16, v15, v6, vcc
    v_cmp_gt_u32 vcc, s90, v7
    v_add_u32 v6, 4096, v6
    s_waitcnt lgkmcnt(0)
    v_cndmask_b32 v17, v15, v6, vcc
    v_mul_f32 v192, v9, v192
    v_mul_f32 v193, v9, v193
    v_mul_f32 v194, v9, v194
    v_mul_f32 v195, v9, v195
    v_fma_f32 v112, v112, s88, v192
    v_fma_f32 v113, v113, s88, v193
    v_fma_f32 v114, v114, s88, v194
    v_fma_f32 v115, v115, s88, v195
    v_cvt_pk_bf16_f32 v112, v112, v113
    v_cvt_pk_bf16_f32 v113, v114, v115
    v_xor_b32 v18, 0, v10
    ds_write_b64 v18, v[112:113] offset:0
    v_mul_f32 v196, v9, v196
    v_mul_f32 v197, v9, v197
    v_mul_f32 v198, v9, v198
    v_mul_f32 v199, v9, v199
    v_fma_f32 v116, v116, s88, v196
    v_fma_f32 v117, v117, s88, v197
    v_fma_f32 v118, v118, s88, v198
    v_fma_f32 v119, v119, s88, v199
    v_cvt_pk_bf16_f32 v116, v116, v117
    v_cvt_pk_bf16_f32 v117, v118, v119
    v_xor_b32 v18, 16, v10
    ds_write_b64 v18, v[116:117] offset:0
    v_mul_f32 v200, v9, v200
    v_mul_f32 v201, v9, v201
    v_mul_f32 v202, v9, v202
    v_mul_f32 v203, v9, v203
    v_fma_f32 v120, v120, s88, v200
    v_fma_f32 v121, v121, s88, v201
    v_fma_f32 v122, v122, s88, v202
    v_fma_f32 v123, v123, s88, v203
    v_cvt_pk_bf16_f32 v120, v120, v121
    v_cvt_pk_bf16_f32 v121, v122, v123
    v_xor_b32 v18, 32, v10
    ds_write_b64 v18, v[120:121] offset:0
    v_mul_f32 v204, v9, v204
    v_mul_f32 v205, v9, v205
    v_mul_f32 v206, v9, v206
    v_mul_f32 v207, v9, v207
    v_fma_f32 v124, v124, s88, v204
    v_fma_f32 v125, v125, s88, v205
    v_fma_f32 v126, v126, s88, v206
    v_fma_f32 v127, v127, s88, v207
    v_cvt_pk_bf16_f32 v124, v124, v125
    v_cvt_pk_bf16_f32 v125, v126, v127
    v_xor_b32 v18, 48, v10
    ds_write_b64 v18, v[124:125] offset:0
    s_waitcnt lgkmcnt(0)
    ds_read_b128 v[20:23], v13 offset:0
    ds_read_b128 v[24:27], v13 offset:1024
    s_waitcnt lgkmcnt(0)
    buffer_store_dwordx4 v[20:23], v16, s[36:39], 0 offen sc1
    buffer_store_dwordx4 v[24:27], v17, s[36:39], 0 offen sc1
    s_nop 1
    ds_read_b128 v[192:195], v5 offset:4096
    ds_read_b128 v[196:199], v5 offset:5120
    ds_read_b128 v[200:203], v5 offset:6144
    ds_read_b128 v[204:207], v5 offset:7168
    ds_read_b128 v[208:211], v5 offset:19456
    ds_read_b128 v[212:215], v5 offset:20480
    ds_read_b128 v[216:219], v5 offset:21504
    ds_read_b128 v[220:223], v5 offset:22528
    s_waitcnt lgkmcnt(4)
    ds_read_b128 v[160:163], v5 offset:34816
    ds_read_b128 v[164:167], v5 offset:35840
    ds_read_b128 v[168:171], v5 offset:36864
    ds_read_b128 v[172:175], v5 offset:37888
    ds_read_b128 v[176:179], v5 offset:50176
    ds_read_b128 v[180:183], v5 offset:51200
    ds_read_b128 v[184:187], v5 offset:52224
    ds_read_b128 v[188:191], v5 offset:53248
    s_lshl_b32 s92, s2, 2
    s_lshl_b32 s93, s45, 1
    s_add_u32 s92, s92, s93
    s_add_u32 s92, s92, 1
    s_mul_i32 s89, s92, 3125
    s_lshr_b32 s89, s89, 7
    s_add_u32 s95, s92, 1
    s_mul_i32 s90, s95, 3125
    s_lshr_b32 s90, s90, 7
    s_sub_u32 s90, s90, s89
    s_lshl_b32 s92, s45, 1
    s_add_u32 s92, s92, 1
    s_lshl_b32 s92, s92, 7
    s_add_u32 s92, s92, 5440
    v_lshlrev_b32 v6, 2, v2
    v_add_u32 v6, s92, v6
    ds_read_b32 v7, v6
    s_waitcnt lgkmcnt(0)
    v_mfma_f32_32x32x16_bf16 v[112:127], v[224:227], v[192:195], 0
    v_mfma_f32_32x32x16_bf16 v[112:127], v[228:231], v[196:199], v[112:127]
    v_mfma_f32_32x32x16_bf16 v[112:127], v[232:235], v[200:203], v[112:127]
    v_mfma_f32_32x32x16_bf16 v[112:127], v[236:239], v[204:207], v[112:127]
    v_mfma_f32_32x32x16_bf16 v[112:127], v[240:243], v[208:211], v[112:127]
    v_mfma_f32_32x32x16_bf16 v[112:127], v[244:247], v[212:215], v[112:127]
    v_mfma_f32_32x32x16_bf16 v[112:127], v[248:251], v[216:219], v[112:127]
    v_mfma_f32_32x32x16_bf16 v[112:127], v[252:255], v[220:223], v[112:127]
    v_mfma_f32_32x32x16_bf16 v[112:127], v[128:131], v[160:163], v[112:127]
    v_mfma_f32_32x32x16_bf16 v[112:127], v[132:135], v[164:167], v[112:127]
    v_mfma_f32_32x32x16_bf16 v[112:127], v[136:139], v[168:171], v[112:127]
    v_mfma_f32_32x32x16_bf16 v[112:127], v[140:143], v[172:175], v[112:127]
    v_mfma_f32_32x32x16_bf16 v[112:127], v[144:147], v[176:179], v[112:127]
    v_mfma_f32_32x32x16_bf16 v[112:127], v[148:151], v[180:183], v[112:127]
    v_mfma_f32_32x32x16_bf16 v[112:127], v[152:155], v[184:187], v[112:127]
    v_mfma_f32_32x32x16_bf16 v[112:127], v[156:159], v[188:191], v[112:127]
    v_cvt_f32_u32 v9, v7
    s_nop 15
    ds_read_b128 v[192:195], v8 offset:0
    ds_read_b128 v[196:199], v8 offset:32
    ds_read_b128 v[200:203], v8 offset:64
    ds_read_b128 v[204:207], v8 offset:96
    v_add_u32 v6, s89, v12
    v_cmp_gt_u32 vcc, s90, v12
    v_lshl_add_u32 v6, v6, 8, v14
    v_add_u32 v7, 16, v12
    v_cndmask_b32 v16, v15, v6, vcc
    v_cmp_gt_u32 vcc, s90, v7
    v_add_u32 v6, 4096, v6
    s_waitcnt lgkmcnt(0)
    v_cndmask_b32 v17, v15, v6, vcc
    v_mul_f32 v192, v9, v192
    v_mul_f32 v193, v9, v193
    v_mul_f32 v194, v9, v194
    v_mul_f32 v195, v9, v195
    v_fma_f32 v112, v112, s88, v192
    v_fma_f32 v113, v113, s88, v193
    v_fma_f32 v114, v114, s88, v194
    v_fma_f32 v115, v115, s88, v195
    v_cvt_pk_bf16_f32 v112, v112, v113
    v_cvt_pk_bf16_f32 v113, v114, v115
    v_xor_b32 v18, 0, v10
    ds_write_b64 v18, v[112:113] offset:2048
    v_mul_f32 v196, v9, v196
    v_mul_f32 v197, v9, v197
    v_mul_f32 v198, v9, v198
    v_mul_f32 v199, v9, v199
    v_fma_f32 v116, v116, s88, v196
    v_fma_f32 v117, v117, s88, v197
    v_fma_f32 v118, v118, s88, v198
    v_fma_f32 v119, v119, s88, v199
    v_cvt_pk_bf16_f32 v116, v116, v117
    v_cvt_pk_bf16_f32 v117, v118, v119
    v_xor_b32 v18, 16, v10
    ds_write_b64 v18, v[116:117] offset:2048
    v_mul_f32 v200, v9, v200
    v_mul_f32 v201, v9, v201
    v_mul_f32 v202, v9, v202
    v_mul_f32 v203, v9, v203
    v_fma_f32 v120, v120, s88, v200
    v_fma_f32 v121, v121, s88, v201
    v_fma_f32 v122, v122, s88, v202
    v_fma_f32 v123, v123, s88, v203
    v_cvt_pk_bf16_f32 v120, v120, v121
    v_cvt_pk_bf16_f32 v121, v122, v123
    v_xor_b32 v18, 32, v10
    ds_write_b64 v18, v[120:121] offset:2048
    v_mul_f32 v204, v9, v204
    v_mul_f32 v205, v9, v205
    v_mul_f32 v206, v9, v206
    v_mul_f32 v207, v9, v207
    v_fma_f32 v124, v124, s88, v204
    v_fma_f32 v125, v125, s88, v205
    v_fma_f32 v126, v126, s88, v206
    v_fma_f32 v127, v127, s88, v207
    v_cvt_pk_bf16_f32 v124, v124, v125
    v_cvt_pk_bf16_f32 v125, v126, v127
    v_xor_b32 v18, 48, v10
    ds_write_b64 v18, v[124:125] offset:2048
    s_waitcnt lgkmcnt(0)
    ds_read_b128 v[20:23], v13 offset:2048
    ds_read_b128 v[24:27], v13 offset:3072
    s_waitcnt lgkmcnt(0)
    buffer_store_dwordx4 v[20:23], v16, s[36:39], 0 offen sc1
    buffer_store_dwordx4 v[24:27], v17, s[36:39], 0 offen sc1
    s_nop 1
    s_branch L_k2_exit
L_k2_slow:
    s_setprio 0
    s_waitcnt vmcnt(0) lgkmcnt(0)
    s_barrier
    s_load_dwordx4 s[4:7], s[0:1], 0
    s_load_dwordx4 s[8:11], s[0:1], 16
    s_load_dwordx4 s[12:15], s[0:1], 32
    s_load_dwordx4 s[64:67], s[0:1], 48
    s_load_dwordx2 s[68:69], s[0:1], 64
    s_load_dwordx2 s[70:71], s[0:1], 80
    s_waitcnt lgkmcnt(0)
    s_mov_b32 s20, s4
    s_and_b32 s21, s5, 0xffff
    s_mov_b32 s22, 6400000
    s_mov_b32 s23, 0x20000
    s_mov_b32 s24, s6
    s_and_b32 s25, s7, 0xffff
    s_mov_b32 s26, 12800000
    s_mov_b32 s27, 0x20000
    s_mov_b32 s28, s8
    s_and_b32 s29, s9, 0xffff
    s_mov_b32 s30, 1600000
    s_mov_b32 s31, 0x20000
    s_mov_b32 s32, s10
    s_and_b32 s33, s11, 0xffff
    s_mov_b32 s34, 1600000
    s_mov_b32 s35, 0x20000
    s_mov_b32 s36, s12
    s_and_b32 s37, s13, 0xffff
    s_mov_b32 s38, 139264
    s_mov_b32 s39, 0x20000
    s_mov_b32 s40, s14
    s_and_b32 s41, s15, 0xffff
    s_mov_b32 s42, 512
    s_mov_b32 s43, 0x20000
    s_mov_b32 s48, s64
    s_and_b32 s49, s65, 0xffff
    s_mov_b32 s50, 65536
    s_mov_b32 s51, 0x20000
    s_mov_b32 s52, s66
    s_and_b32 s53, s67, 0xffff
    s_mov_b32 s54, 256
    s_mov_b32 s55, 0x20000
    s_mov_b32 s56, s68
    s_and_b32 s57, s69, 0xffff
    s_mov_b32 s58, 6400000
    s_mov_b32 s59, 0x20000
    s_mov_b32 s60, s70
    s_and_b32 s61, s71, 0xffff
    s_mov_b32 s62, 12800000
    s_mov_b32 s63, 0x20000
    s_lshl_b32 s72, s2, 2
    s_mul_i32 s73, s72, 3125
    s_lshr_b32 s73, s73, 7
    s_add_u32 s72, s72, 4
    s_mul_i32 s74, s72, 3125
    s_lshr_b32 s74, s74, 7
    s_sub_u32 s75, s74, s73
    s_mov_b32 s76, 0xbfb8aa3b
    s_mov_b32 s77, 0xbf317218
    v_lshrrev_b32 v1, 6, v0
    s_nop 0
    v_readfirstlane_b32 s78, v1
    v_and_b32 v2, 255, v0
    v_lshlrev_b32 v3, 4, v0
    v_mov_b32 v4, 0
    v_mov_b32 v5, 0
    v_mov_b32 v6, 0
    v_mov_b32 v7, 0
    s_mov_b32 s79, 0
L_sl_zero:
    v_add_u32 v8, s79, v3
    ds_write_b128 v8, v[4:7]
    s_add_u32 s79, s79, 8192
    s_cmp_lt_u32 s79, 100352
    s_cbranch_scc1 L_sl_zero
    v_lshlrev_b32 v8, 2, v0
    v_add_u32 v8, 150528, v8
    ds_write_b32 v8, v4
    ds_write_b32 v8, v4 offset:2048
    s_waitcnt lgkmcnt(0)
    s_barrier
    v_lshlrev_b32 v9, 1, v2
    buffer_load_ushort v10, v9, s[40:43], 0 offen
    s_lshr_b32 s79, s78, 2
    s_waitcnt vmcnt(0)
    v_lshlrev_b32 v10, 16, v10
L_sl_qn:
    s_cmp_ge_u32 s79, s75
    s_cbranch_scc1 L_sl_qdone
    s_add_u32 s80, s79, s73
    s_lshl_b32 s80, s80, 8
    v_mov_b32 v11, v10
    v_mov_b32 v12, s80
    v_add_u32 v13, 65536, v9
    s_mov_b32 s81, 0
L_sl_qk:
    buffer_load_ushort v14, v12, s[20:23], 0 offen
    buffer_load_ushort v15, v13, s[36:39], 0 offen
    buffer_load_ushort v16, v12, s[20:23], 0 offen offset:2
    buffer_load_ushort v17, v13, s[36:39], 0 offen offset:512
    v_add_u32 v12, 4, v12
    v_add_u32 v13, 1024, v13
    s_waitcnt vmcnt(0)
    v_lshlrev_b32 v14, 16, v14
    v_lshlrev_b32 v15, 16, v15
    v_lshlrev_b32 v16, 16, v16
    v_lshlrev_b32 v17, 16, v17
    v_fmac_f32 v11, v14, v15
    v_fmac_f32 v11, v16, v17
    s_add_u32 s81, s81, 2
    s_cmp_lt_u32 s81, 128
    s_cbranch_scc1 L_sl_qk
    v_mul_f32 v11, s76, v11
    v_cvt_pk_bf16_f32 v11, v11, v11
    s_lshl_b32 s80, s79, 9
    v_add_u32 v12, s80, v9
    v_add_u32 v12, 100352, v12
    ds_write_b16 v12, v11
    s_add_u32 s79, s79, 2
    s_branch L_sl_qn
L_sl_qdone:
    v_add_u32 v12, 131072, v9
    buffer_load_ushort v32, v12, s[36:39], 0 offen
    v_add_u32 v12, 131584, v9
    buffer_load_ushort v33, v12, s[36:39], 0 offen
    v_add_u32 v12, 132096, v9
    buffer_load_ushort v34, v12, s[36:39], 0 offen
    v_add_u32 v12, 132608, v9
    buffer_load_ushort v35, v12, s[36:39], 0 offen
    v_add_u32 v12, 133120, v9
    buffer_load_ushort v36, v12, s[36:39], 0 offen
    v_add_u32 v12, 133632, v9
    buffer_load_ushort v37, v12, s[36:39], 0 offen
    v_add_u32 v12, 134144, v9
    buffer_load_ushort v38, v12, s[36:39], 0 offen
    v_add_u32 v12, 134656, v9
    buffer_load_ushort v39, v12, s[36:39], 0 offen
    v_add_u32 v12, 135168, v9
    buffer_load_ushort v40, v12, s[36:39], 0 offen
    v_add_u32 v12, 135680, v9
    buffer_load_ushort v41, v12, s[36:39], 0 offen
    v_add_u32 v12, 136192, v9
    buffer_load_ushort v42, v12, s[36:39], 0 offen
    v_add_u32 v12, 136704, v9
    buffer_load_ushort v43, v12, s[36:39], 0 offen
    v_add_u32 v12, 137216, v9
    buffer_load_ushort v44, v12, s[36:39], 0 offen
    v_add_u32 v12, 137728, v9
    buffer_load_ushort v45, v12, s[36:39], 0 offen
    v_add_u32 v12, 138240, v9
    buffer_load_ushort v46, v12, s[36:39], 0 offen
    v_add_u32 v12, 138752, v9
    buffer_load_ushort v47, v12, s[36:39], 0 offen
    v_and_b32 v12, 31, v2
    v_bfe_u32 v13, v12, 2, 1
    v_lshlrev_b32 v13, 4, v13
    v_lshrrev_b32 v14, 3, v12
    v_lshl_add_u32 v13, v14, 2, v13
    v_and_b32 v14, 3, v12
    v_add_u32 v13, v13, v14
    v_lshrrev_b32 v14, 5, v2
    v_lshlrev_b32 v14, 6, v14
    v_lshl_add_u32 v18, v13, 1, v14
    s_waitcnt vmcnt(0)
    v_lshlrev_b32 v32, 16, v32
    v_mul_f32 v32, s76, v32
    v_lshlrev_b32 v33, 16, v33
    v_mul_f32 v33, s76, v33
    v_lshlrev_b32 v34, 16, v34
    v_mul_f32 v34, s76, v34
    v_lshlrev_b32 v35, 16, v35
    v_mul_f32 v35, s76, v35
    v_lshlrev_b32 v36, 16, v36
    v_mul_f32 v36, s76, v36
    v_lshlrev_b32 v37, 16, v37
    v_mul_f32 v37, s76, v37
    v_lshlrev_b32 v38, 16, v38
    v_mul_f32 v38, s76, v38
    v_lshlrev_b32 v39, 16, v39
    v_mul_f32 v39, s76, v39
    v_lshlrev_b32 v40, 16, v40
    v_mul_f32 v40, s76, v40
    v_lshlrev_b32 v41, 16, v41
    v_mul_f32 v41, s76, v41
    v_lshlrev_b32 v42, 16, v42
    v_mul_f32 v42, s76, v42
    v_lshlrev_b32 v43, 16, v43
    v_mul_f32 v43, s76, v43
    v_lshlrev_b32 v44, 16, v44
    v_mul_f32 v44, s76, v44
    v_lshlrev_b32 v45, 16, v45
    v_mul_f32 v45, s76, v45
    v_lshlrev_b32 v46, 16, v46
    v_mul_f32 v46, s76, v46
    v_lshlrev_b32 v47, 16, v47
    v_mul_f32 v47, s76, v47
    s_waitcnt lgkmcnt(0)
    s_barrier
    s_mov_b32 s79, 0
L_sl_scan:
    v_add_u32 v12, s79, v0
    v_lshlrev_b32 v13, 2, v12
    buffer_load_dword v14, v13, s[32:35], 0 offen
    s_mov_b32 s80, 400000
    v_cmp_gt_u32 s[82:83], s80, v12
    s_waitcnt vmcnt(0)
    v_cmp_le_u32 vcc, s73, v14
    s_and_b64 s[82:83], s[82:83], vcc
    v_cmp_gt_u32 vcc, s74, v14
    s_and_b64 s[82:83], s[82:83], vcc
    v_mov_b32 v15, 150528
    v_mov_b32 v16, 1
    v_mov_b32 v17, 0
    s_mov_b64 exec, s[82:83]
    s_cbranch_execz L_sl_noapp
    ds_add_rtn_u32 v17, v15, v16
    s_waitcnt lgkmcnt(0)
    v_lshl_add_u32 v17, v17, 2, v15
    ds_write_b32 v17, v12 offset:4
L_sl_noapp:
    s_mov_b64 exec, -1
    s_waitcnt lgkmcnt(0)
    s_barrier
    v_mov_b32 v15, 150528
    ds_read_b32 v16, v15
    s_waitcnt lgkmcnt(0)
    v_readfirstlane_b32 s80, v16
    s_cmp_ge_u32 s78, 4
    s_cbranch_scc1 L_sl_edone
    s_mov_b32 s81, 0
L_sl_edge:
    s_cmp_ge_u32 s81, s80
    s_cbranch_scc1 L_sl_edone
    s_lshl_b32 s84, s81, 2
    v_mov_b32 v15, s84
    v_add_u32 v15, 150532, v15
    ds_read_b32 v19, v15
    s_waitcnt lgkmcnt(0)
    v_lshlrev_b32 v20, 2, v19
    v_lshlrev_b32 v21, 5, v19
    buffer_load_dword v22, v20, s[28:31], 0 offen
    buffer_load_dword v23, v20, s[32:35], 0 offen
    buffer_load_dwordx4 v[24:27], v21, s[24:27], 0 offen
    buffer_load_dwordx4 v[28:31], v21, s[24:27], 0 offen offset:16
    s_waitcnt vmcnt(2)
    v_lshl_add_u32 v22, v22, 9, v18
    buffer_load_ushort v48, v22, s[60:63], 0 offen
    v_subrev_u32 v23, s73, v23
    v_lshl_add_u32 v49, v23, 9, v9
    v_add_u32 v49, 100352, v49
    ds_read_u16 v50, v49
    v_lshlrev_b32 v51, 10, v23
    v_lshl_add_u32 v51, v2, 2, v51
    ds_read_b32 v52, v51
    s_waitcnt vmcnt(0) lgkmcnt(0)
    v_lshlrev_b32 v48, 16, v48
    v_lshlrev_b32 v50, 16, v50
    v_add_f32 v48, v48, v50
    v_lshlrev_b32 v53, 16, v24
    v_and_b32 v54, 0xffff0000, v24
    v_fmac_f32 v48, v53, v32
    v_fmac_f32 v48, v54, v33
    v_lshlrev_b32 v53, 16, v25
    v_and_b32 v54, 0xffff0000, v25
    v_fmac_f32 v48, v53, v34
    v_fmac_f32 v48, v54, v35
    v_lshlrev_b32 v53, 16, v26
    v_and_b32 v54, 0xffff0000, v26
    v_fmac_f32 v48, v53, v36
    v_fmac_f32 v48, v54, v37
    v_lshlrev_b32 v53, 16, v27
    v_and_b32 v54, 0xffff0000, v27
    v_fmac_f32 v48, v53, v38
    v_fmac_f32 v48, v54, v39
    v_lshlrev_b32 v53, 16, v28
    v_and_b32 v54, 0xffff0000, v28
    v_fmac_f32 v48, v53, v40
    v_fmac_f32 v48, v54, v41
    v_lshlrev_b32 v53, 16, v29
    v_and_b32 v54, 0xffff0000, v29
    v_fmac_f32 v48, v53, v42
    v_fmac_f32 v48, v54, v43
    v_lshlrev_b32 v53, 16, v30
    v_and_b32 v54, 0xffff0000, v30
    v_fmac_f32 v48, v53, v44
    v_fmac_f32 v48, v54, v45
    v_lshlrev_b32 v53, 16, v31
    v_and_b32 v54, 0xffff0000, v31
    v_fmac_f32 v48, v53, v46
    v_fmac_f32 v48, v54, v47
    v_exp_f32 v53, v48
    s_nop 0
    v_add_f32 v53, 1.0, v53
    v_rcp_f32 v53, v53
    s_nop 0
    v_fmac_f32 v52, v48, v53
    ds_write_b32 v51, v52
    s_cmp_eq_u32 s78, 0
    s_cbranch_scc0 L_sl_nodeg
    v_lshlrev_b32 v53, 2, v23
    v_mov_b32 v54, 1
    v_add_u32 v53, 152832, v53
    s_mov_b64 exec, 1
    ds_add_u32 v53, v54
    s_mov_b64 exec, -1
L_sl_nodeg:
    s_waitcnt lgkmcnt(0)
    s_add_u32 s81, s81, 1
    s_branch L_sl_edge
L_sl_edone:
    s_waitcnt lgkmcnt(0)
    s_barrier
    v_mov_b32 v15, 150528
    v_mov_b32 v16, 0
    ds_write_b32 v15, v16
    s_waitcnt lgkmcnt(0)
    s_barrier
    s_add_u32 s79, s79, 512
    s_cmp_lt_u32 s79, 400000
    s_cbranch_scc1 L_sl_scan
    v_and_b32 v2, 127, v0
    v_lshlrev_b32 v9, 1, v2
    buffer_load_ushort v10, v9, s[52:55], 0 offen
    s_lshr_b32 s79, s78, 1
    s_waitcnt vmcnt(0)
    v_lshlrev_b32 v10, 16, v10
L_sl_on:
    s_cmp_ge_u32 s79, s75
    s_cbranch_scc1 L_k2_exit
    s_lshl_b32 s80, s79, 10
    v_mov_b32 v12, s80
    v_mov_b32 v13, v9
    v_mov_b32 v11, 0
    s_mov_b32 s81, 0
L_sl_ou:
    ds_read_b64 v[14:15], v12
    buffer_load_ushort v16, v13, s[48:51], 0 offen
    buffer_load_ushort v17, v13, s[48:51], 0 offen offset:256
    v_add_u32 v12, 8, v12
    v_add_u32 v13, 512, v13
    s_waitcnt vmcnt(0) lgkmcnt(0)
    v_lshlrev_b32 v16, 16, v16
    v_lshlrev_b32 v17, 16, v17
    v_fmac_f32 v11, v14, v16
    v_fmac_f32 v11, v15, v17
    s_add_u32 s81, s81, 2
    s_cmp_lt_u32 s81, 256
    s_cbranch_scc1 L_sl_ou
    s_lshl_b32 s80, s79, 2
    v_mov_b32 v12, s80
    v_add_u32 v12, 152832, v12
    ds_read_b32 v14, v12
    s_waitcnt lgkmcnt(0)
    v_cvt_f32_u32 v14, v14
    v_mul_f32 v11, s77, v11
    v_fmac_f32 v11, v14, v10
    v_cvt_pk_bf16_f32 v11, v11, v11
    s_add_u32 s80, s79, s73
    s_lshl_b32 s80, s80, 8
    v_add_u32 v12, s80, v9
    buffer_store_short v11, v12, s[56:59], 0 offen
    s_add_u32 s79, s79, 4
    s_branch L_sl_on
L_k2_exit:
    s_waitcnt vmcnt(0) lgkmcnt(0)
    s_endpgm
L_code_end:
    .fill 64, 4, 0xbf800000

.section .rodata,"a"
.p2align 6
.amdhsa_kernel mpnn_edge_kernel
  .amdhsa_next_free_vgpr 256
  .amdhsa_next_free_sgpr 96
  .amdhsa_accum_offset 256
  .amdhsa_group_segment_fixed_size 0
  .amdhsa_kernarg_size 88
  .amdhsa_user_sgpr_count 2
  .amdhsa_user_sgpr_kernarg_segment_ptr 1
  .amdhsa_system_sgpr_workgroup_id_x 1
.end_amdhsa_kernel
.text
```
